```python
import torch

def _softmax(x, axis=-1):
    return torch.softmax(x, dim=axis)
def _gelu(x):
    return torch.nn.functional.gelu(x, approximate="tanh")
def _silu(x):
    return torch.nn.functional.silu(x)
def _sigmoid(x):
    return torch.sigmoid(x)
def _layernorm(x, axis=-1, eps=1e-5):
    m = x.mean(dim=axis, keepdim=True)
    v = x.var(dim=axis, keepdim=True, unbiased=False)
    return (x - m) / torch.sqrt(v + eps)
def _scatter_add(tgt, idx, src, axis=0):
    return tgt.clone().index_add_(axis, idx, src)
def _segment_sum(src, seg, n):
    out = torch.zeros((n,) + src.shape[1:], dtype=src.dtype)
    return out.index_add_(0, seg, src)
def _pad(x, pw):
    flat = tuple(v for pair in reversed(pw) for v in pair)
    return torch.nn.functional.pad(x, flat)

kernel_name = 'gated_mix__ssm_conv_s4d__dense_activation_squared_relu__prompt'

def setup_inputs():

    _w = (lambda a: (lambda t: t.to(torch.bfloat16) if t.is_floating_point() else t)(torch.as_tensor(a)))
    def _A_setup():
        Bsz, L, D, N = 1, 2048, 640, 128
        return {
            "u": _w((lambda *s: torch.randn(*s, dtype=torch.bfloat16) * 0.05)(Bsz, L, D)),
            "log_A_real": _w((lambda *s: torch.randn(*s, dtype=torch.bfloat16) * 6.4)(D, N) * 0.5),
            "A_imag": _w((lambda *s: torch.randn(*s, dtype=torch.bfloat16) * 0.1)(D, N) * 3.14),
            "C_real": _w((lambda *s: torch.randn(*s, dtype=torch.bfloat16) * 0.4)(D, N) / N ** 0.5),
            "C_imag": _w((lambda *s: torch.randn(*s, dtype=torch.bfloat16) * 0.4)(D, N) / N ** 0.5),
            "log_dt": _w((lambda *s: torch.randn(*s, dtype=torch.bfloat16) * 0.1)(D) * 0.5 - 4.0),
            "D_skip": _w((lambda *s: torch.randn(*s, dtype=torch.bfloat16) * 0.1)(D)),
        }
    _A_in = _A_setup()

    def _B_setup():
        B, S, D, F = 1, 2048, 640, 1728
        return {
            "x": _w((lambda *s: torch.randn(*s, dtype=torch.bfloat16) * 0.05)(B, S, D)),
            "w1": _w((lambda *s: torch.randn(*s, dtype=torch.bfloat16) * 0.05)(D, F)),
            "b1": _w((lambda *s: torch.randn(*s, dtype=torch.bfloat16) * 0.05)(F)),
            "w2": _w((lambda *s: torch.randn(*s, dtype=torch.bfloat16) * 0.05)(F, D)),
            "b2": _w((lambda *s: torch.randn(*s, dtype=torch.bfloat16) * 0.05)(D)),
        }
    _B_in = _B_setup()

    return {
        "A_u": _A_in["u"],
        "A_log_A_real": _A_in["log_A_real"],
        "A_A_imag": _A_in["A_imag"],
        "A_C_real": _A_in["C_real"],
        "A_C_imag": _A_in["C_imag"],
        "A_log_dt": _A_in["log_dt"],
        "A_D_skip": _A_in["D_skip"],
        "B_x": _B_in["x"],
        "B_w1": _B_in["w1"],
        "B_b1": _B_in["b1"],
        "B_w2": _B_in["w2"],
        "B_b2": _B_in["b2"],
        "gate_w": _w((lambda *s: torch.randn(*s, dtype=torch.bfloat16) * 0.05)(640) * 16.0),
    }

def reference(A_u, A_log_A_real, A_A_imag, A_C_real, A_C_imag, A_log_dt, A_D_skip, B_x, B_w1, B_b1, B_w2, B_b2, gate_w):
    def _A_ref(u, log_A_real, A_imag, C_real, C_imag, log_dt, D_skip):
        L = u.shape[1]
        dt = torch.exp(log_dt)
        A = -torch.exp(log_A_real) + 1j * A_imag
        C = (C_real + 1j * C_imag) * dt[:, None]
        pos = (lambda x, dt: x.to(dt))(torch.arange(L), log_dt.dtype)
        P = torch.exp((A * dt[:, None])[:, :, None] * pos[None, None, :])
        K = 2.0 * torch.einsum("dn,dnl->dl", C, P).real
        L2 = 2 * L
        u_t = (lambda x, *d: x.permute(*d))(u, 0, 2, 1)
        Kf = (lambda x, *a, **k: torch.fft.rfft(x.float(), *a, **k))(K, L2)
        Uf = (lambda x, *a, **k: torch.fft.rfft(x.float(), *a, **k))(u_t, L2)
        y = (lambda x, *a, **k: torch.fft.irfft(x, *a, **k).to(torch.bfloat16))(Uf * Kf[None, :, :], L2)[:, :, :L]
        y = (lambda x, *d: x.permute(*d))(y, 0, 2, 1)
        return y + u * D_skip[None, None, :]

    def _B_ref(x, w1, b1, w2, b2):
        h = torch.einsum("bsd,df->bsf", x, w1) + b1
        zero = torch.zeros_like(h)
        r = torch.where(h > zero, h, zero)
        h = r * r
        out = torch.einsum("bsf,fd->bsd", h, w2) + b2
        return out

    x = A_u
    g = _sigmoid((x * gate_w).sum(-1, keepdims=True))
    a = _A_ref(x, A_log_A_real, A_A_imag, A_C_real, A_C_imag, A_log_dt, A_D_skip)
    b = _B_ref(x, B_w1, B_b1, B_w2, B_b2)
    return g * a + (1 - g) * b
```

```asm
; @launch kernel=k1_kernel grid=(256,1,1) block=(512,1,1) lds=163840
; @launch kernel=k2_kernel grid=(416,1,1) block=(256,1,1) lds=81920
.amdgcn_target "amdgcn-amd-amdhsa--gfx950"
.text
.globl k1_kernel
.p2align 8
.type k1_kernel,@function
k1_kernel:
s_cmp_ge_u32 s2, 256
s_cbranch_scc1 K1_END
s_load_dwordx16 s[16:31], s[0:1], 0
s_load_dwordx16 s[32:47], s[0:1], 64
s_cmp_ge_u32 s2, 224
s_cbranch_scc1 K1_T
s_and_b32 s4, s2, 7
s_lshr_b32 s5, s2, 3
s_mul_i32 s6, s5, 37
s_lshr_b32 s6, s6, 8
s_mul_i32 s7, s6, 7
s_sub_u32 s5, s5, s7
s_add_u32 s3, s5, s6
s_and_b32 s7, s4, 1
s_mul_i32 s7, s7, 7
s_add_u32 s5, s5, s7
s_lshr_b32 s4, s4, 1
s_lshl_b32 s4, s4, 2
s_add_u32 s4, s4, s6
v_lshrrev_b32 v1, 6, v0
v_and_b32 v2, 63, v0
v_readfirstlane_b32 s8, v1
v_and_b32 v3, 15, v2
v_lshrrev_b32 v4, 4, v2
s_waitcnt lgkmcnt(0)
s_cmp_lt_u32 s8, 4
s_cbranch_scc1 G1C_1
s_mov_b32 s48, s16
s_mov_b32 s49, s17
s_mov_b32 s50, 0x280000
s_mov_b32 s51, 0x20000
s_mov_b32 s52, s32
s_mov_b32 s53, s33
s_mov_b32 s54, 0x21c000
s_mov_b32 s55, 0x20000
s_sub_u32 s8, s8, 4
v_lshrrev_b32 v5, 3, v2
v_and_b32 v6, 7, v2
v_xor_b32 v6, v6, v4
s_lshl_b32 s9, s4, 7
s_lshl_b32 s10, s8, 5
s_add_u32 s9, s9, s10
v_add_u32 v5, s9, v5
v_mul_u32_u24 v5, 1280, v5
v_lshl_add_u32 v10, v6, 4, v5
v_xor_b32 v6, 4, v6
v_lshl_add_u32 v11, v6, 4, v5
v_bfe_u32 v5, v2, 2, 2
s_lshl_b32 s10, s8, 3
v_add_u32 v5, s10, v5
v_mul_u32_u24 v5, 3456, v5
s_lshl_b32 s11, s5, 8
v_add_u32 v5, s11, v5
v_and_b32 v6, 3, v2
s_and_b32 s10, s8, 1
s_lshl_b32 s10, s10, 1
v_xor_b32 v6, s10, v6
v_lshl_add_u32 v6, v4, 2, v6
v_lshl_add_u32 v12, v6, 4, v5
s_lshl_b32 s12, s8, 11
s_lshl_b32 s17, s8, 12
s_mul_i32 s18, s3, 3
s_mul_i32 s19, s18, 26
s_lshr_b32 s19, s19, 8
s_mul_i32 s19, s19, 10
s_sub_u32 s18, s18, s19
s_sub_u32 s14, s3, s6
v_lshrrev_b32 v5, 1, v2
v_lshlrev_b32 v5, 2, v5
v_add_u32 v5, s6, v5
v_mul_u32_u24 v5, 3456, v5
v_and_b32 v6, 1, v2
v_lshl_add_u32 v5, v6, 7, v5
v_add_u32 v13, s11, v5
v_and_b32 v6, 31, v2
v_mul_u32_u24 v6, 7, v6
v_add_u32 v6, s14, v6
v_min_u32 v6, 127, v6
s_lshl_b32 s9, s4, 7
v_add_u32 v6, s9, v6
v_mul_u32_u24 v6, 1280, v6
v_lshrrev_b32 v7, 5, v2
v_lshl_add_u32 v14, v7, 7, v6
s_lshl_b32 s20, s18, 7
s_mul_i32 s25, s18, 221184
s_add_u32 s18, s18, 1
s_cmp_eq_u32 s18, 10
s_cselect_b32 s18, 0, s18
s_add_u32 m0, s12, 81920
s_add_u32 s13, s25, 0
buffer_load_dwordx4 v12, s[52:55], s13 offen lds
s_add_u32 m0, s12, 82944
s_add_u32 s13, s25, 13824
buffer_load_dwordx4 v12, s[52:55], s13 offen lds
s_add_u32 m0, s17, 0
s_add_u32 s13, s20, 0
buffer_load_dwordx4 v10, s[48:51], s13 offen lds
s_add_u32 m0, s17, 1024
s_add_u32 s13, s20, 10240
buffer_load_dwordx4 v11, s[48:51], s13 offen lds
s_add_u32 m0, s17, 2048
s_add_u32 s13, s20, 20480
buffer_load_dwordx4 v10, s[48:51], s13 offen lds
s_add_u32 m0, s17, 3072
s_add_u32 s13, s20, 30720
buffer_load_dwordx4 v11, s[48:51], s13 offen lds
s_add_u32 m0, s12, 90112
s_add_u32 s13, s25, 110592
buffer_load_dwordx4 v12, s[52:55], s13 offen lds
s_add_u32 m0, s12, 91136
s_add_u32 s13, s25, 124416
buffer_load_dwordx4 v12, s[52:55], s13 offen lds
s_lshl_b32 s21, s18, 7
s_mul_i32 s26, s18, 221184
s_add_u32 s18, s18, 1
s_cmp_eq_u32 s18, 10
s_cselect_b32 s18, 0, s18
s_add_u32 m0, s12, 98304
s_add_u32 s13, s26, 0
buffer_load_dwordx4 v12, s[52:55], s13 offen lds
s_add_u32 m0, s12, 99328
s_add_u32 s13, s26, 13824
buffer_load_dwordx4 v12, s[52:55], s13 offen lds
s_add_u32 m0, s17, 16384
s_add_u32 s13, s21, 0
buffer_load_dwordx4 v10, s[48:51], s13 offen lds
s_add_u32 m0, s17, 17408
s_add_u32 s13, s21, 10240
buffer_load_dwordx4 v11, s[48:51], s13 offen lds
s_add_u32 m0, s17, 18432
s_add_u32 s13, s21, 20480
buffer_load_dwordx4 v10, s[48:51], s13 offen lds
s_add_u32 m0, s17, 19456
s_add_u32 s13, s21, 30720
buffer_load_dwordx4 v11, s[48:51], s13 offen lds
s_add_u32 m0, s12, 106496
s_add_u32 s13, s26, 110592
buffer_load_dwordx4 v12, s[52:55], s13 offen lds
s_add_u32 m0, s12, 107520
s_add_u32 s13, s26, 124416
buffer_load_dwordx4 v12, s[52:55], s13 offen lds
s_add_u32 s9, s8, 1
s_mul_i32 s10, s9, 442368
s_lshl_b32 s9, s9, 8
buffer_load_dword v20, v13, s[52:55], s10 offen
buffer_load_dword v21, v14, s[48:51], s9 offen
s_lshl_b32 s22, s18, 7
s_mul_i32 s27, s18, 221184
s_add_u32 s18, s18, 1
s_cmp_eq_u32 s18, 10
s_cselect_b32 s18, 0, s18
s_add_u32 m0, s12, 114688
s_add_u32 s13, s27, 0
buffer_load_dwordx4 v12, s[52:55], s13 offen lds
s_add_u32 m0, s12, 115712
s_add_u32 s13, s27, 13824
buffer_load_dwordx4 v12, s[52:55], s13 offen lds
s_add_u32 m0, s17, 32768
s_add_u32 s13, s22, 0
buffer_load_dwordx4 v10, s[48:51], s13 offen lds
s_add_u32 m0, s17, 33792
s_add_u32 s13, s22, 10240
buffer_load_dwordx4 v11, s[48:51], s13 offen lds
s_add_u32 m0, s17, 34816
s_add_u32 s13, s22, 20480
buffer_load_dwordx4 v10, s[48:51], s13 offen lds
s_add_u32 m0, s17, 35840
s_add_u32 s13, s22, 30720
buffer_load_dwordx4 v11, s[48:51], s13 offen lds
s_add_u32 m0, s12, 122880
s_add_u32 s13, s27, 110592
buffer_load_dwordx4 v12, s[52:55], s13 offen lds
s_add_u32 m0, s12, 123904
s_add_u32 s13, s27, 124416
buffer_load_dwordx4 v12, s[52:55], s13 offen lds
s_add_u32 s60, s46, 0xa00000
s_addc_u32 s61, s47, 0
s_mov_b32 s62, 0x280000
s_mov_b32 s63, 0x20000
s_lshl_b32 s64, s5, 2
s_add_u32 s64, s64, s8
s_min_u32 s64, s64, 39
s_mul_i32 s65, s64, 26
s_lshr_b32 s65, s65, 8
s_mul_i32 s66, s65, 10
s_sub_u32 s66, s64, s66
s_lshl_b32 s65, s65, 5
s_lshl_b32 s67, s4, 7
s_add_u32 s65, s65, s67
s_lshl_b32 s68, s8, 13
s_add_u32 s68, s68, 81920
v_lshrrev_b32 v16, 3, v2
v_mul_u32_u24 v16, 1280, v16
v_and_b32 v6, 7, v2
v_lshl_add_u32 v16, v6, 4, v16
s_mul_i32 s69, s65, 1280
s_lshl_b32 s67, s66, 7
s_add_u32 s69, s69, s67
v_bfe_u32 v6, v2, 2, 2
v_and_b32 v7, 3, v2
v_lshlrev_b32 v17, 3, v4
v_add_u32 v17, 3, v17
v_sub_u32 v17, v17, v6
v_lshlrev_b32 v17, 7, v17
v_lshl_add_u32 v17, v7, 3, v17
v_add_u32 v17, s68, v17
v_lshlrev_b32 v18, 6, v3
v_sub_u32 v19, 3, v4
v_lshl_add_u32 v18, v19, 4, v18
v_add_u32 v18, s68, v18
v_lshlrev_b32 v19, 4, v2
v_add_u32 v19, s68, v19
v_lshrrev_b32 v22, 2, v2
v_lshlrev_b32 v22, 12, v22
v_lshl_add_u32 v22, v7, 4, v22
s_lshl_b32 s70, s66, 18
s_lshl_b32 s67, s65, 1
s_sub_u32 s67, 4032, s67
s_add_u32 s70, s70, s67
s_waitcnt vmcnt(20)
s_barrier
s_waitcnt vmcnt(18)
s_barrier
s_lshl_b32 s23, s18, 7
s_mul_i32 s28, s18, 221184
s_add_u32 s18, s18, 1
s_cmp_eq_u32 s18, 10
s_cselect_b32 s18, 0, s18
s_add_u32 m0, s12, 131072
s_add_u32 s13, s28, 0
buffer_load_dwordx4 v12, s[52:55], s13 offen lds
s_add_u32 m0, s12, 132096
s_add_u32 s13, s28, 13824
buffer_load_dwordx4 v12, s[52:55], s13 offen lds
s_add_u32 m0, s17, 49152
s_add_u32 s13, s23, 0
buffer_load_dwordx4 v10, s[48:51], s13 offen lds
s_add_u32 m0, s17, 50176
s_add_u32 s13, s23, 10240
buffer_load_dwordx4 v11, s[48:51], s13 offen lds
s_waitcnt vmcnt(16)
s_barrier
s_add_u32 m0, s17, 51200
s_add_u32 s13, s23, 20480
buffer_load_dwordx4 v10, s[48:51], s13 offen lds
s_add_u32 m0, s17, 52224
s_add_u32 s13, s23, 30720
buffer_load_dwordx4 v11, s[48:51], s13 offen lds
s_add_u32 m0, s12, 139264
s_add_u32 s13, s28, 110592
buffer_load_dwordx4 v12, s[52:55], s13 offen lds
s_add_u32 m0, s12, 140288
s_add_u32 s13, s28, 124416
buffer_load_dwordx4 v12, s[52:55], s13 offen lds
s_waitcnt vmcnt(18)
s_barrier
s_lshl_b32 s24, s18, 7
s_mul_i32 s29, s18, 221184
s_add_u32 s18, s18, 1
s_cmp_eq_u32 s18, 10
s_cselect_b32 s18, 0, s18
s_add_u32 m0, s12, 147456
s_add_u32 s13, s29, 0
buffer_load_dwordx4 v12, s[52:55], s13 offen lds
s_add_u32 m0, s12, 148480
s_add_u32 s13, s29, 13824
buffer_load_dwordx4 v12, s[52:55], s13 offen lds
s_add_u32 m0, s17, 65536
s_add_u32 s13, s24, 0
buffer_load_dwordx4 v10, s[48:51], s13 offen lds
s_add_u32 m0, s17, 66560
s_add_u32 s13, s24, 10240
buffer_load_dwordx4 v11, s[48:51], s13 offen lds
s_waitcnt vmcnt(14)
s_barrier
s_add_u32 m0, s17, 67584
s_add_u32 s13, s24, 20480
buffer_load_dwordx4 v10, s[48:51], s13 offen lds
s_add_u32 m0, s17, 68608
s_add_u32 s13, s24, 30720
buffer_load_dwordx4 v11, s[48:51], s13 offen lds
s_add_u32 m0, s12, 155648
s_add_u32 s13, s29, 110592
buffer_load_dwordx4 v12, s[52:55], s13 offen lds
s_add_u32 m0, s12, 156672
s_add_u32 s13, s29, 124416
buffer_load_dwordx4 v12, s[52:55], s13 offen lds
s_waitcnt vmcnt(16)
s_barrier
s_lshl_b32 s20, s18, 7
s_mul_i32 s25, s18, 221184
s_add_u32 s18, s18, 1
s_cmp_eq_u32 s18, 10
s_cselect_b32 s18, 0, s18
s_add_u32 m0, s12, 81920
s_add_u32 s13, s25, 0
buffer_load_dwordx4 v12, s[52:55], s13 offen lds
s_add_u32 m0, s12, 82944
s_add_u32 s13, s25, 13824
buffer_load_dwordx4 v12, s[52:55], s13 offen lds
s_add_u32 m0, s17, 0
s_add_u32 s13, s20, 0
buffer_load_dwordx4 v10, s[48:51], s13 offen lds
s_add_u32 m0, s17, 1024
s_add_u32 s13, s20, 10240
buffer_load_dwordx4 v11, s[48:51], s13 offen lds
s_waitcnt vmcnt(14)
s_barrier
s_add_u32 m0, s17, 2048
s_add_u32 s13, s20, 20480
buffer_load_dwordx4 v10, s[48:51], s13 offen lds
s_add_u32 m0, s17, 3072
s_add_u32 s13, s20, 30720
buffer_load_dwordx4 v11, s[48:51], s13 offen lds
s_add_u32 m0, s12, 90112
s_add_u32 s13, s25, 110592
buffer_load_dwordx4 v12, s[52:55], s13 offen lds
s_add_u32 m0, s12, 91136
s_add_u32 s13, s25, 124416
buffer_load_dwordx4 v12, s[52:55], s13 offen lds
s_waitcnt vmcnt(16)
s_barrier
s_lshl_b32 s21, s18, 7
s_mul_i32 s26, s18, 221184
s_add_u32 s18, s18, 1
s_cmp_eq_u32 s18, 10
s_cselect_b32 s18, 0, s18
s_add_u32 m0, s12, 98304
s_add_u32 s13, s26, 0
buffer_load_dwordx4 v12, s[52:55], s13 offen lds
s_add_u32 m0, s12, 99328
s_add_u32 s13, s26, 13824
buffer_load_dwordx4 v12, s[52:55], s13 offen lds
s_add_u32 m0, s17, 16384
s_add_u32 s13, s21, 0
buffer_load_dwordx4 v10, s[48:51], s13 offen lds
s_add_u32 m0, s17, 17408
s_add_u32 s13, s21, 10240
buffer_load_dwordx4 v11, s[48:51], s13 offen lds
s_waitcnt vmcnt(14)
s_barrier
s_add_u32 m0, s17, 18432
s_add_u32 s13, s21, 20480
buffer_load_dwordx4 v10, s[48:51], s13 offen lds
s_add_u32 m0, s17, 19456
s_add_u32 s13, s21, 30720
buffer_load_dwordx4 v11, s[48:51], s13 offen lds
s_add_u32 m0, s12, 106496
s_add_u32 s13, s26, 110592
buffer_load_dwordx4 v12, s[52:55], s13 offen lds
s_add_u32 m0, s12, 107520
s_add_u32 s13, s26, 124416
buffer_load_dwordx4 v12, s[52:55], s13 offen lds
s_waitcnt vmcnt(16)
s_barrier
s_lshl_b32 s22, s18, 7
s_mul_i32 s27, s18, 221184
s_add_u32 s18, s18, 1
s_cmp_eq_u32 s18, 10
s_cselect_b32 s18, 0, s18
s_add_u32 m0, s12, 114688
s_add_u32 s13, s27, 0
buffer_load_dwordx4 v12, s[52:55], s13 offen lds
s_add_u32 m0, s12, 115712
s_add_u32 s13, s27, 13824
buffer_load_dwordx4 v12, s[52:55], s13 offen lds
s_add_u32 m0, s17, 32768
s_add_u32 s13, s22, 0
buffer_load_dwordx4 v10, s[48:51], s13 offen lds
s_add_u32 m0, s17, 33792
s_add_u32 s13, s22, 10240
buffer_load_dwordx4 v11, s[48:51], s13 offen lds
s_waitcnt vmcnt(14)
s_barrier
s_add_u32 m0, s17, 34816
s_add_u32 s13, s22, 20480
buffer_load_dwordx4 v10, s[48:51], s13 offen lds
s_add_u32 m0, s17, 35840
s_add_u32 s13, s22, 30720
buffer_load_dwordx4 v11, s[48:51], s13 offen lds
s_add_u32 m0, s12, 122880
s_add_u32 s13, s27, 110592
buffer_load_dwordx4 v12, s[52:55], s13 offen lds
s_add_u32 m0, s12, 123904
s_add_u32 s13, s27, 124416
buffer_load_dwordx4 v12, s[52:55], s13 offen lds
s_waitcnt vmcnt(16)
s_barrier
s_lshl_b32 s23, s18, 7
s_mul_i32 s28, s18, 221184
s_add_u32 s18, s18, 1
s_cmp_eq_u32 s18, 10
s_cselect_b32 s18, 0, s18
s_add_u32 m0, s12, 131072
s_add_u32 s13, s28, 0
buffer_load_dwordx4 v12, s[52:55], s13 offen lds
s_add_u32 m0, s12, 132096
s_add_u32 s13, s28, 13824
buffer_load_dwordx4 v12, s[52:55], s13 offen lds
s_add_u32 m0, s17, 49152
s_add_u32 s13, s23, 0
buffer_load_dwordx4 v10, s[48:51], s13 offen lds
s_add_u32 m0, s17, 50176
s_add_u32 s13, s23, 10240
buffer_load_dwordx4 v11, s[48:51], s13 offen lds
s_waitcnt vmcnt(14)
s_barrier
s_add_u32 m0, s17, 51200
s_add_u32 s13, s23, 20480
buffer_load_dwordx4 v10, s[48:51], s13 offen lds
s_add_u32 m0, s17, 52224
s_add_u32 s13, s23, 30720
buffer_load_dwordx4 v11, s[48:51], s13 offen lds
s_add_u32 m0, s12, 139264
s_add_u32 s13, s28, 110592
buffer_load_dwordx4 v12, s[52:55], s13 offen lds
s_add_u32 m0, s12, 140288
s_add_u32 s13, s28, 124416
buffer_load_dwordx4 v12, s[52:55], s13 offen lds
s_waitcnt vmcnt(16)
s_barrier
s_lshl_b32 s24, s18, 7
s_mul_i32 s29, s18, 221184
s_add_u32 s18, s18, 1
s_cmp_eq_u32 s18, 10
s_cselect_b32 s18, 0, s18
s_add_u32 m0, s12, 147456
s_add_u32 s13, s29, 0
buffer_load_dwordx4 v12, s[52:55], s13 offen lds
s_add_u32 m0, s12, 148480
s_add_u32 s13, s29, 13824
buffer_load_dwordx4 v12, s[52:55], s13 offen lds
s_add_u32 m0, s17, 65536
s_add_u32 s13, s24, 0
buffer_load_dwordx4 v10, s[48:51], s13 offen lds
s_add_u32 m0, s17, 66560
s_add_u32 s13, s24, 10240
buffer_load_dwordx4 v11, s[48:51], s13 offen lds
s_waitcnt vmcnt(14)
s_barrier
s_add_u32 m0, s17, 67584
s_add_u32 s13, s24, 20480
buffer_load_dwordx4 v10, s[48:51], s13 offen lds
s_add_u32 m0, s17, 68608
s_add_u32 s13, s24, 30720
buffer_load_dwordx4 v11, s[48:51], s13 offen lds
s_add_u32 m0, s12, 155648
s_add_u32 s13, s29, 110592
buffer_load_dwordx4 v12, s[52:55], s13 offen lds
s_add_u32 m0, s12, 156672
s_add_u32 s13, s29, 124416
buffer_load_dwordx4 v12, s[52:55], s13 offen lds
s_waitcnt vmcnt(16)
s_barrier
s_add_u32 m0, s68, 0
s_nop 0
buffer_load_dwordx4 v16, s[48:51], s69 offen lds
s_add_u32 s69, s69, 10240
s_add_u32 m0, s68, 1024
s_nop 0
buffer_load_dwordx4 v16, s[48:51], s69 offen lds
s_add_u32 s69, s69, 10240
s_add_u32 m0, s68, 2048
s_nop 0
buffer_load_dwordx4 v16, s[48:51], s69 offen lds
s_add_u32 s69, s69, 10240
s_add_u32 m0, s68, 3072
s_nop 0
buffer_load_dwordx4 v16, s[48:51], s69 offen lds
s_waitcnt vmcnt(14)
s_barrier
s_waitcnt vmcnt(12)
s_barrier
s_waitcnt vmcnt(6)
s_barrier
s_waitcnt vmcnt(4)
s_barrier
s_lshl_b32 s9, s5, 2
s_add_u32 s9, s9, s8
s_cmp_ge_u32 s9, 40
s_cbranch_scc1 G1U2_2
s_waitcnt vmcnt(0)
ds_read_b64_tr_b16 v[24:25], v17 offset:512
ds_read_b64_tr_b16 v[26:27], v17 offset:0
ds_read_b64_tr_b16 v[28:29], v17 offset:544
ds_read_b64_tr_b16 v[30:31], v17 offset:32
ds_read_b64_tr_b16 v[32:33], v17 offset:576
ds_read_b64_tr_b16 v[34:35], v17 offset:64
ds_read_b64_tr_b16 v[36:37], v17 offset:608
ds_read_b64_tr_b16 v[38:39], v17 offset:96
s_waitcnt lgkmcnt(0)
ds_write_b128 v18, v[24:27] offset:4096
ds_write_b128 v18, v[28:31] offset:5120
ds_write_b128 v18, v[32:35] offset:6144
ds_write_b128 v18, v[36:39] offset:7168
ds_read_b128 v[40:43], v19 offset:4096
ds_read_b128 v[44:47], v19 offset:5120
ds_read_b128 v[48:51], v19 offset:6144
ds_read_b128 v[52:55], v19 offset:7168
s_waitcnt lgkmcnt(3)
buffer_store_dwordx4 v[40:43], v22, s[60:63], s70 offen sc1
s_add_u32 s70, s70, 65536
s_waitcnt lgkmcnt(2)
buffer_store_dwordx4 v[44:47], v22, s[60:63], s70 offen sc1
s_add_u32 s70, s70, 65536
s_waitcnt lgkmcnt(1)
buffer_store_dwordx4 v[48:51], v22, s[60:63], s70 offen sc1
s_add_u32 s70, s70, 65536
s_waitcnt lgkmcnt(0)
buffer_store_dwordx4 v[52:55], v22, s[60:63], s70 offen sc1
s_add_u32 s70, s70, 65536
G1U2_2:
s_endpgm
G1C_1:
s_mov_b32 s56, s34
s_mov_b32 s57, s35
s_mov_b32 s58, 0xd80
s_mov_b32 s59, 0x20000
s_mov_b32 s60, s46
s_mov_b32 s61, s47
s_mov_b32 s62, 0x6c0000
s_mov_b32 s63, 0x20000
s_lshr_b32 s15, s8, 1
s_lshl_b32 s11, s5, 8
s_lshl_b32 s10, s15, 7
s_add_u32 s10, s10, s11
v_lshlrev_b32 v5, 3, v4
v_add_u32 v5, s10, v5
s_mul_i32 s14, s2, 3
s_add_u32 s14, s14, s8
s_cmp_ge_u32 s8, 3
s_cbranch_scc1 G1NK_3b
s_cmp_ge_u32 s14, 640
s_cbranch_scc1 G1NK_3b
buffer_load_dwordx2 v[216:217], v5, s[56:59], 0 offen offset:0
buffer_load_dwordx2 v[218:219], v5, s[56:59], 0 offen offset:32
buffer_load_dwordx2 v[220:221], v5, s[56:59], 0 offen offset:64
buffer_load_dwordx2 v[222:223], v5, s[56:59], 0 offen offset:96
s_mov_b32 s4, s14
s_lshl_b32 s9, s8, 14
s_add_u32 s9, s9, 45056
s_cmp_eq_u32 s8, 2
s_cselect_b32 s9, 126976, s9
s_mov_b32 s48, s18
s_mov_b32 s49, s19
s_mov_b32 s50, 0x28000
s_mov_b32 s51, 0x20000
s_mov_b32 s52, s20
s_mov_b32 s53, s21
s_mov_b32 s54, 0x28000
s_mov_b32 s55, 0x20000
s_mov_b32 s56, s22
s_mov_b32 s57, s23
s_mov_b32 s58, 0x28000
s_mov_b32 s59, 0x20000
s_mov_b32 s60, s24
s_mov_b32 s61, s25
s_mov_b32 s62, 0x28000
s_mov_b32 s63, 0x20000
s_mov_b32 s64, s26
s_mov_b32 s65, s27
s_mov_b32 s66, 0x500
s_mov_b32 s67, 0x20000
s_mov_b32 s68, s28
s_mov_b32 s69, s29
s_mov_b32 s70, 0x500
s_mov_b32 s71, 0x20000
s_lshl_b32 s10, s4, 8
v_lshlrev_b32 v5, 1, v2
buffer_load_ushort v8, v5, s[48:51], s10 offen offset:0
buffer_load_ushort v10, v5, s[52:55], s10 offen offset:0
buffer_load_ushort v12, v5, s[56:59], s10 offen offset:0
buffer_load_ushort v14, v5, s[60:63], s10 offen offset:0
buffer_load_ushort v9, v5, s[48:51], s10 offen offset:128
buffer_load_ushort v11, v5, s[52:55], s10 offen offset:128
buffer_load_ushort v13, v5, s[56:59], s10 offen offset:128
buffer_load_ushort v15, v5, s[60:63], s10 offen offset:128
s_lshl_b32 s11, s4, 1
v_mov_b32 v6, 0
buffer_load_ushort v16, v6, s[64:67], s11 offen
buffer_load_ushort v17, v6, s[68:71], s11 offen
v_lshlrev_b32 v7, 4, v2
s_add_u32 s15, s9, 4096
v_mul_u32_u24 v6, 240, v2
v_add_u32 v128, s15, v6
v_bfe_u32 v5, v2, 2, 2
v_and_b32 v6, 1, v4
v_lshl_or_b32 v5, v6, 2, v5
v_lshrrev_b32 v6, 1, v4
v_lshlrev_b32 v6, 4, v6
v_lshl_add_u32 v6, v5, 1, v6
v_mul_u32_u24 v6, 240, v6
v_and_b32 v18, 3, v2
v_lshl_add_u32 v6, v18, 3, v6
v_add_u32 v129, s15, v6
s_waitcnt vmcnt(0)
v_lshlrev_b32 v8, 16, v8
v_lshlrev_b32 v9, 16, v9
v_lshlrev_b32 v10, 16, v10
v_lshlrev_b32 v11, 16, v11
v_lshlrev_b32 v12, 16, v12
v_lshlrev_b32 v13, 16, v13
v_lshlrev_b32 v14, 16, v14
v_lshlrev_b32 v15, 16, v15
v_lshlrev_b32 v16, 16, v16
v_lshlrev_b32 v17, 16, v17
v_mul_f32 v16, 0x3fb8aa3b, v16
v_exp_f32 v16, v16
v_max3_f32 v18, abs(v12), abs(v13), abs(v14)
v_cvt_pk_bf16_f32 v16, v16, v16
v_max_f32 v18, abs(v15), v18
v_and_b32 v16, 0xffff0000, v16
s_nop 0
v_max_f32_dpp v18, v18, v18 row_ror:8 row_mask:0xf bank_mask:0xf
s_nop 1
v_max_f32_dpp v18, v18, v18 row_ror:4 row_mask:0xf bank_mask:0xf
s_nop 1
v_max_f32_dpp v18, v18, v18 row_ror:2 row_mask:0xf bank_mask:0xf
s_nop 1
v_max_f32_dpp v18, v18, v18 row_ror:1 row_mask:0xf bank_mask:0xf
s_nop 0
v_readlane_b32 s96, v18, 0
v_readlane_b32 s97, v18, 16
v_readlane_b32 s98, v18, 32
v_readlane_b32 s99, v18, 48
s_max_u32 s96, s96, s97
s_max_u32 s98, s98, s99
s_max_u32 s96, s96, s98
s_lshr_b32 s96, s96, 23
s_max_u32 s96, s96, 1
s_min_u32 s96, s96, 252
s_sub_u32 s97, 253, s96
s_lshl_b32 s97, s97, 23
s_add_u32 s98, s96, 2
s_lshl_b32 s98, s98, 23
v_mul_f32 v12, s97, v12
v_mul_f32 v13, s97, v13
v_mul_f32 v14, s97, v14
v_mul_f32 v15, s97, v15
v_mul_f32 v19, s98, v16
v_mul_f32 v28, 0x3fb8aa3b, v8
v_mul_f32 v138, 0x3fb8aa3b, v9
v_exp_f32 v28, v28
v_exp_f32 v138, v138
v_mul_f32 v29, v16, v10
v_mul_f32 v139, v16, v11
v_cvt_pk_bf16_f32 v28, v28, v28
v_cvt_pk_bf16_f32 v138, v138, v138
v_mul_f32 v29, 0x3e22f983, v29
v_mul_f32 v139, 0x3e22f983, v139
v_and_b32 v28, 0xffff0000, v28
v_and_b32 v138, 0xffff0000, v138
v_mul_f32 v28, v16, v28
v_mul_f32 v138, v16, v138
v_mul_f32 v28, 0xbfb8aa3b, v28
v_mul_f32 v138, 0xbfb8aa3b, v138
v_mul_f32 v20, 1.0, v28
v_mul_f32 v130, 1.0, v138
v_mul_f32 v21, 1.0, v29
v_mul_f32 v131, 1.0, v139
v_exp_f32 v20, v20
v_exp_f32 v130, v130
v_fract_f32 v21, v21
v_fract_f32 v131, v131
v_cos_f32 v96, v21
v_cos_f32 v224, v131
v_sin_f32 v97, v21
v_sin_f32 v225, v131
v_mul_f32 v96, v96, v20
v_mul_f32 v224, v224, v130
v_mul_f32 v97, v97, v20
v_mul_f32 v225, v225, v130
v_mul_f32 v20, 0x42000000, v28
v_mul_f32 v130, 0x42000000, v138
v_mul_f32 v21, 0x42000000, v29
v_mul_f32 v131, 0x42000000, v139
v_exp_f32 v20, v20
v_exp_f32 v130, v130
v_fract_f32 v21, v21
v_fract_f32 v131, v131
v_cos_f32 v106, v21
v_cos_f32 v234, v131
v_sin_f32 v107, v21
v_sin_f32 v235, v131
v_mul_f32 v106, v106, v20
v_mul_f32 v234, v234, v130
v_mul_f32 v107, v107, v20
v_mul_f32 v235, v235, v130
v_mul_f32 v20, v97, v97
v_mul_f32 v130, v225, v225
v_add_f32 v21, v96, v96
v_add_f32 v131, v224, v224
v_fma_f32 v98, v96, v96, -v20
v_fma_f32 v226, v224, v224, -v130
v_mul_f32 v99, v21, v97
v_mul_f32 v227, v131, v225
v_mul_f32 v22, v107, v107
v_mul_f32 v132, v235, v235
v_add_f32 v23, v106, v106
v_add_f32 v133, v234, v234
v_fma_f32 v108, v106, v106, -v22
v_fma_f32 v236, v234, v234, -v132
v_mul_f32 v109, v23, v107
v_mul_f32 v237, v133, v235
v_mul_f32 v20, v99, v99
v_mul_f32 v130, v227, v227
v_add_f32 v21, v98, v98
v_add_f32 v131, v226, v226
v_fma_f32 v100, v98, v98, -v20
v_fma_f32 v228, v226, v226, -v130
v_mul_f32 v101, v21, v99
v_mul_f32 v229, v131, v227
v_mul_f32 v22, v109, v109
v_mul_f32 v132, v237, v237
v_add_f32 v23, v108, v108
v_add_f32 v133, v236, v236
v_fma_f32 v110, v108, v108, -v22
v_fma_f32 v238, v236, v236, -v132
v_mul_f32 v111, v23, v109
v_mul_f32 v239, v133, v237
v_mul_f32 v20, v101, v101
v_mul_f32 v130, v229, v229
v_add_f32 v21, v100, v100
v_add_f32 v131, v228, v228
v_fma_f32 v102, v100, v100, -v20
v_fma_f32 v230, v228, v228, -v130
v_mul_f32 v103, v21, v101
v_mul_f32 v231, v131, v229
v_mul_f32 v22, v111, v111
v_mul_f32 v132, v239, v239
v_add_f32 v23, v110, v110
v_add_f32 v133, v238, v238
v_fma_f32 v112, v110, v110, -v22
v_fma_f32 v240, v238, v238, -v132
v_mul_f32 v113, v23, v111
v_mul_f32 v241, v133, v239
v_mul_f32 v20, v103, v103
v_mul_f32 v130, v231, v231
v_add_f32 v21, v102, v102
v_add_f32 v131, v230, v230
v_fma_f32 v104, v102, v102, -v20
v_fma_f32 v232, v230, v230, -v130
v_mul_f32 v105, v21, v103
v_mul_f32 v233, v131, v231
v_mul_f32 v22, v113, v113
v_mul_f32 v132, v241, v241
v_add_f32 v23, v112, v112
v_add_f32 v133, v240, v240
v_fma_f32 v114, v112, v112, -v22
v_fma_f32 v242, v240, v240, -v132
v_mul_f32 v115, v23, v113
v_mul_f32 v243, v133, v241
v_mul_f32 v20, v115, v115
v_mul_f32 v130, v243, v243
v_add_f32 v21, v114, v114
v_add_f32 v131, v242, v242
v_fma_f32 v116, v114, v114, -v20
v_fma_f32 v244, v242, v242, -v130
v_mul_f32 v117, v21, v115
v_mul_f32 v245, v131, v243
v_mul_f32 v22, v117, v117
v_mul_f32 v132, v245, v245
v_add_f32 v23, v116, v116
v_add_f32 v133, v244, v244
v_fma_f32 v118, v116, v116, -v22
v_fma_f32 v246, v244, v244, -v132
v_mul_f32 v119, v23, v117
v_mul_f32 v247, v133, v245
v_cvt_pk_f16_f32 v120, v98, v99
v_cvt_pk_f16_f32 v248, v226, v227
v_cvt_pk_f16_f32 v121, v100, v101
v_cvt_pk_f16_f32 v249, v228, v229
v_cvt_pk_f16_f32 v122, v104, v105
v_cvt_pk_f16_f32 v250, v232, v233
v_cvt_pk_f16_f32 v123, v106, v107
v_cvt_pk_f16_f32 v251, v234, v235
v_cvt_pk_f16_f32 v124, v108, v109
v_cvt_pk_f16_f32 v252, v236, v237
v_cvt_pk_f16_f32 v125, v110, v111
v_cvt_pk_f16_f32 v253, v238, v239
v_cvt_pk_f16_f32 v126, v112, v113
v_cvt_pk_f16_f32 v254, v240, v241
v_cvt_pk_f16_f32 v127, v114, v115
v_cvt_pk_f16_f32 v255, v242, v243
v_cvt_pk_f16_f32 v72, 1.0, v102
v_cvt_pk_f16_f32 v200, 1.0, v230
v_cvt_pk_f16_f32 v80, 0, v103
v_cvt_pk_f16_f32 v208, 0, v231
v_sub_f32 v30, 0, v14
v_sub_f32 v140, 0, v15
v_mul_f32 v20, v30, v97
v_mul_f32 v130, v140, v225
v_mul_f32 v21, v30, v96
v_mul_f32 v131, v140, v224
v_fma_f32 v24, v12, v96, v20
v_fma_f32 v134, v13, v224, v130
v_fma_f32 v25, -v12, v97, v21
v_fma_f32 v135, -v13, v225, v131
v_cvt_pk_f16_f32 v32, v12, v24
v_cvt_pk_f16_f32 v160, v13, v134
v_cvt_pk_f16_f32 v52, v30, v25
v_cvt_pk_f16_f32 v180, v140, v135
v_mul_f32 v20, v30, v113
v_mul_f32 v130, v140, v241
v_mul_f32 v21, v30, v112
v_mul_f32 v131, v140, v240
v_fma_f32 v24, v12, v112, v20
v_fma_f32 v134, v13, v240, v130
v_fma_f32 v25, -v12, v113, v21
v_fma_f32 v135, -v13, v241, v131
v_mul_f32 v20, v25, v99
v_mul_f32 v130, v135, v227
v_mul_f32 v21, v25, v98
v_mul_f32 v131, v135, v226
v_fma_f32 v26, v24, v98, v20
v_fma_f32 v136, v134, v226, v130
v_fma_f32 v27, -v24, v99, v21
v_fma_f32 v137, -v134, v227, v131
v_cvt_pk_f16_f32 v40, v24, v26
v_cvt_pk_f16_f32 v168, v134, v136
v_cvt_pk_f16_f32 v60, v25, v27
v_cvt_pk_f16_f32 v188, v135, v137
v_mul_f32 v20, v30, v115
v_mul_f32 v130, v140, v243
v_mul_f32 v21, v30, v114
v_mul_f32 v131, v140, v242
v_fma_f32 v24, v12, v114, v20
v_fma_f32 v134, v13, v242, v130
v_fma_f32 v25, -v12, v115, v21
v_fma_f32 v135, -v13, v243, v131
v_mul_f32 v20, v25, v101
v_mul_f32 v130, v135, v229
v_mul_f32 v21, v25, v100
v_mul_f32 v131, v135, v228
v_fma_f32 v26, v24, v100, v20
v_fma_f32 v136, v134, v228, v130
v_fma_f32 v27, -v24, v101, v21
v_fma_f32 v137, -v134, v229, v131
v_cvt_pk_f16_f32 v44, v24, v26
v_cvt_pk_f16_f32 v172, v134, v136
v_cvt_pk_f16_f32 v64, v25, v27
v_cvt_pk_f16_f32 v192, v135, v137
v_mul_f32 v20, v30, v117
v_mul_f32 v130, v140, v245
v_mul_f32 v21, v30, v116
v_mul_f32 v131, v140, v244
v_fma_f32 v24, v12, v116, v20
v_fma_f32 v134, v13, v244, v130
v_fma_f32 v25, -v12, v117, v21
v_fma_f32 v135, -v13, v245, v131
v_mul_f32 v20, v25, v111
v_mul_f32 v130, v135, v239
v_mul_f32 v21, v25, v110
v_mul_f32 v131, v135, v238
v_fma_f32 v26, v24, v110, v20
v_fma_f32 v136, v134, v238, v130
v_fma_f32 v27, -v24, v111, v21
v_fma_f32 v137, -v134, v239, v131
v_cvt_pk_f16_f32 v48, v24, v26
v_cvt_pk_f16_f32 v176, v134, v136
v_cvt_pk_f16_f32 v68, v25, v27
v_cvt_pk_f16_f32 v196, v135, v137
v_mul_f32 v20, v30, v119
v_mul_f32 v130, v140, v247
v_mul_f32 v21, v30, v118
v_mul_f32 v131, v140, v246
v_fma_f32 v24, v12, v118, v20
v_fma_f32 v134, v13, v246, v130
v_fma_f32 v25, -v12, v119, v21
v_fma_f32 v135, -v13, v247, v131
v_mov_b32 v144, v24
v_mov_b32 v145, v134
v_pk_mul_f16 v22, v72, v122 op_sel:[0,0] op_sel_hi:[1,0]
v_pk_mul_f16 v132, v200, v250 op_sel:[0,0] op_sel_hi:[1,0]
v_pk_mul_f16 v23, v72, v122 op_sel:[0,1] op_sel_hi:[1,1]
v_pk_mul_f16 v133, v200, v250 op_sel:[0,1] op_sel_hi:[1,1]
v_pk_fma_f16 v73, v80, v122, v22 op_sel:[0,1,0] op_sel_hi:[1,1,1] neg_lo:[0,1,0] neg_hi:[0,1,0]
v_pk_fma_f16 v201, v208, v250, v132 op_sel:[0,1,0] op_sel_hi:[1,1,1] neg_lo:[0,1,0] neg_hi:[0,1,0]
v_pk_fma_f16 v81, v80, v122, v23 op_sel:[0,0,0] op_sel_hi:[1,0,1]
v_pk_fma_f16 v209, v208, v250, v133 op_sel:[0,0,0] op_sel_hi:[1,0,1]
v_pk_mul_f16 v22, v72, v123 op_sel:[0,0] op_sel_hi:[1,0]
v_pk_mul_f16 v132, v200, v251 op_sel:[0,0] op_sel_hi:[1,0]
v_pk_mul_f16 v23, v72, v123 op_sel:[0,1] op_sel_hi:[1,1]
v_pk_mul_f16 v133, v200, v251 op_sel:[0,1] op_sel_hi:[1,1]
v_pk_fma_f16 v74, v80, v123, v22 op_sel:[0,1,0] op_sel_hi:[1,1,1] neg_lo:[0,1,0] neg_hi:[0,1,0]
v_pk_fma_f16 v202, v208, v251, v132 op_sel:[0,1,0] op_sel_hi:[1,1,1] neg_lo:[0,1,0] neg_hi:[0,1,0]
v_pk_fma_f16 v82, v80, v123, v23 op_sel:[0,0,0] op_sel_hi:[1,0,1]
v_pk_fma_f16 v210, v208, v251, v133 op_sel:[0,0,0] op_sel_hi:[1,0,1]
v_pk_mul_f16 v22, v73, v123 op_sel:[0,0] op_sel_hi:[1,0]
v_pk_mul_f16 v132, v201, v251 op_sel:[0,0] op_sel_hi:[1,0]
v_pk_mul_f16 v23, v73, v123 op_sel:[0,1] op_sel_hi:[1,1]
v_pk_mul_f16 v133, v201, v251 op_sel:[0,1] op_sel_hi:[1,1]
v_pk_fma_f16 v75, v81, v123, v22 op_sel:[0,1,0] op_sel_hi:[1,1,1] neg_lo:[0,1,0] neg_hi:[0,1,0]
v_pk_fma_f16 v203, v209, v251, v132 op_sel:[0,1,0] op_sel_hi:[1,1,1] neg_lo:[0,1,0] neg_hi:[0,1,0]
v_pk_fma_f16 v83, v81, v123, v23 op_sel:[0,0,0] op_sel_hi:[1,0,1]
v_pk_fma_f16 v211, v209, v251, v133 op_sel:[0,0,0] op_sel_hi:[1,0,1]
v_pk_mul_f16 v22, v72, v124 op_sel:[0,0] op_sel_hi:[1,0]
v_pk_mul_f16 v132, v200, v252 op_sel:[0,0] op_sel_hi:[1,0]
v_pk_mul_f16 v23, v72, v124 op_sel:[0,1] op_sel_hi:[1,1]
v_pk_mul_f16 v133, v200, v252 op_sel:[0,1] op_sel_hi:[1,1]
v_pk_fma_f16 v76, v80, v124, v22 op_sel:[0,1,0] op_sel_hi:[1,1,1] neg_lo:[0,1,0] neg_hi:[0,1,0]
v_pk_fma_f16 v204, v208, v252, v132 op_sel:[0,1,0] op_sel_hi:[1,1,1] neg_lo:[0,1,0] neg_hi:[0,1,0]
v_pk_fma_f16 v84, v80, v124, v23 op_sel:[0,0,0] op_sel_hi:[1,0,1]
v_pk_fma_f16 v212, v208, v252, v133 op_sel:[0,0,0] op_sel_hi:[1,0,1]
v_pk_mul_f16 v22, v73, v124 op_sel:[0,0] op_sel_hi:[1,0]
v_pk_mul_f16 v132, v201, v252 op_sel:[0,0] op_sel_hi:[1,0]
v_pk_mul_f16 v23, v73, v124 op_sel:[0,1] op_sel_hi:[1,1]
v_pk_mul_f16 v133, v201, v252 op_sel:[0,1] op_sel_hi:[1,1]
v_pk_fma_f16 v77, v81, v124, v22 op_sel:[0,1,0] op_sel_hi:[1,1,1] neg_lo:[0,1,0] neg_hi:[0,1,0]
v_pk_fma_f16 v205, v209, v252, v132 op_sel:[0,1,0] op_sel_hi:[1,1,1] neg_lo:[0,1,0] neg_hi:[0,1,0]
v_pk_fma_f16 v85, v81, v124, v23 op_sel:[0,0,0] op_sel_hi:[1,0,1]
v_pk_fma_f16 v213, v209, v252, v133 op_sel:[0,0,0] op_sel_hi:[1,0,1]
v_pk_mul_f16 v22, v74, v124 op_sel:[0,0] op_sel_hi:[1,0]
v_pk_mul_f16 v132, v202, v252 op_sel:[0,0] op_sel_hi:[1,0]
v_pk_mul_f16 v23, v74, v124 op_sel:[0,1] op_sel_hi:[1,1]
v_pk_mul_f16 v133, v202, v252 op_sel:[0,1] op_sel_hi:[1,1]
v_pk_fma_f16 v78, v82, v124, v22 op_sel:[0,1,0] op_sel_hi:[1,1,1] neg_lo:[0,1,0] neg_hi:[0,1,0]
v_pk_fma_f16 v206, v210, v252, v132 op_sel:[0,1,0] op_sel_hi:[1,1,1] neg_lo:[0,1,0] neg_hi:[0,1,0]
v_pk_fma_f16 v86, v82, v124, v23 op_sel:[0,0,0] op_sel_hi:[1,0,1]
v_pk_fma_f16 v214, v210, v252, v133 op_sel:[0,0,0] op_sel_hi:[1,0,1]
v_pk_mul_f16 v22, v75, v124 op_sel:[0,0] op_sel_hi:[1,0]
v_pk_mul_f16 v132, v203, v252 op_sel:[0,0] op_sel_hi:[1,0]
v_pk_mul_f16 v23, v75, v124 op_sel:[0,1] op_sel_hi:[1,1]
v_pk_mul_f16 v133, v203, v252 op_sel:[0,1] op_sel_hi:[1,1]
v_pk_fma_f16 v79, v83, v124, v22 op_sel:[0,1,0] op_sel_hi:[1,1,1] neg_lo:[0,1,0] neg_hi:[0,1,0]
v_pk_fma_f16 v207, v211, v252, v132 op_sel:[0,1,0] op_sel_hi:[1,1,1] neg_lo:[0,1,0] neg_hi:[0,1,0]
v_pk_fma_f16 v87, v83, v124, v23 op_sel:[0,0,0] op_sel_hi:[1,0,1]
v_pk_fma_f16 v215, v211, v252, v133 op_sel:[0,0,0] op_sel_hi:[1,0,1]
v_pk_mul_f16 v22, v32, v120 op_sel:[0,0] op_sel_hi:[1,0]
v_pk_mul_f16 v132, v160, v248 op_sel:[0,0] op_sel_hi:[1,0]
v_pk_mul_f16 v23, v32, v120 op_sel:[0,1] op_sel_hi:[1,1] neg_lo:[0,1] neg_hi:[0,1]
v_pk_mul_f16 v133, v160, v248 op_sel:[0,1] op_sel_hi:[1,1] neg_lo:[0,1] neg_hi:[0,1]
v_pk_fma_f16 v33, v52, v120, v22 op_sel:[0,1,0] op_sel_hi:[1,1,1]
v_pk_fma_f16 v161, v180, v248, v132 op_sel:[0,1,0] op_sel_hi:[1,1,1]
v_pk_fma_f16 v53, v52, v120, v23 op_sel:[0,0,0] op_sel_hi:[1,0,1]
v_pk_fma_f16 v181, v180, v248, v133 op_sel:[0,0,0] op_sel_hi:[1,0,1]
v_pk_mul_f16 v22, v32, v121 op_sel:[0,0] op_sel_hi:[1,0]
v_pk_mul_f16 v132, v160, v249 op_sel:[0,0] op_sel_hi:[1,0]
v_pk_mul_f16 v23, v32, v121 op_sel:[0,1] op_sel_hi:[1,1] neg_lo:[0,1] neg_hi:[0,1]
v_pk_mul_f16 v133, v160, v249 op_sel:[0,1] op_sel_hi:[1,1] neg_lo:[0,1] neg_hi:[0,1]
v_pk_fma_f16 v34, v52, v121, v22 op_sel:[0,1,0] op_sel_hi:[1,1,1]
v_pk_fma_f16 v162, v180, v249, v132 op_sel:[0,1,0] op_sel_hi:[1,1,1]
v_pk_fma_f16 v54, v52, v121, v23 op_sel:[0,0,0] op_sel_hi:[1,0,1]
v_pk_fma_f16 v182, v180, v249, v133 op_sel:[0,0,0] op_sel_hi:[1,0,1]
v_pk_mul_f16 v22, v33, v121 op_sel:[0,0] op_sel_hi:[1,0]
v_pk_mul_f16 v132, v161, v249 op_sel:[0,0] op_sel_hi:[1,0]
v_pk_mul_f16 v23, v33, v121 op_sel:[0,1] op_sel_hi:[1,1] neg_lo:[0,1] neg_hi:[0,1]
v_pk_mul_f16 v133, v161, v249 op_sel:[0,1] op_sel_hi:[1,1] neg_lo:[0,1] neg_hi:[0,1]
v_pk_fma_f16 v35, v53, v121, v22 op_sel:[0,1,0] op_sel_hi:[1,1,1]
v_pk_fma_f16 v163, v181, v249, v132 op_sel:[0,1,0] op_sel_hi:[1,1,1]
v_pk_fma_f16 v55, v53, v121, v23 op_sel:[0,0,0] op_sel_hi:[1,0,1]
v_pk_fma_f16 v183, v181, v249, v133 op_sel:[0,0,0] op_sel_hi:[1,0,1]
v_pk_mul_f16 v22, v32, v125 op_sel:[0,0] op_sel_hi:[1,0]
v_pk_mul_f16 v132, v160, v253 op_sel:[0,0] op_sel_hi:[1,0]
v_pk_mul_f16 v23, v32, v125 op_sel:[0,1] op_sel_hi:[1,1] neg_lo:[0,1] neg_hi:[0,1]
v_pk_mul_f16 v133, v160, v253 op_sel:[0,1] op_sel_hi:[1,1] neg_lo:[0,1] neg_hi:[0,1]
v_pk_fma_f16 v36, v52, v125, v22 op_sel:[0,1,0] op_sel_hi:[1,1,1]
v_pk_fma_f16 v164, v180, v253, v132 op_sel:[0,1,0] op_sel_hi:[1,1,1]
v_pk_fma_f16 v56, v52, v125, v23 op_sel:[0,0,0] op_sel_hi:[1,0,1]
v_pk_fma_f16 v184, v180, v253, v133 op_sel:[0,0,0] op_sel_hi:[1,0,1]
v_pk_mul_f16 v22, v33, v125 op_sel:[0,0] op_sel_hi:[1,0]
v_pk_mul_f16 v132, v161, v253 op_sel:[0,0] op_sel_hi:[1,0]
v_pk_mul_f16 v23, v33, v125 op_sel:[0,1] op_sel_hi:[1,1] neg_lo:[0,1] neg_hi:[0,1]
v_pk_mul_f16 v133, v161, v253 op_sel:[0,1] op_sel_hi:[1,1] neg_lo:[0,1] neg_hi:[0,1]
v_pk_fma_f16 v37, v53, v125, v22 op_sel:[0,1,0] op_sel_hi:[1,1,1]
v_pk_fma_f16 v165, v181, v253, v132 op_sel:[0,1,0] op_sel_hi:[1,1,1]
v_pk_fma_f16 v57, v53, v125, v23 op_sel:[0,0,0] op_sel_hi:[1,0,1]
v_pk_fma_f16 v185, v181, v253, v133 op_sel:[0,0,0] op_sel_hi:[1,0,1]
v_pk_mul_f16 v22, v34, v125 op_sel:[0,0] op_sel_hi:[1,0]
v_pk_mul_f16 v132, v162, v253 op_sel:[0,0] op_sel_hi:[1,0]
v_pk_mul_f16 v23, v34, v125 op_sel:[0,1] op_sel_hi:[1,1] neg_lo:[0,1] neg_hi:[0,1]
v_pk_mul_f16 v133, v162, v253 op_sel:[0,1] op_sel_hi:[1,1] neg_lo:[0,1] neg_hi:[0,1]
v_pk_fma_f16 v38, v54, v125, v22 op_sel:[0,1,0] op_sel_hi:[1,1,1]
v_pk_fma_f16 v166, v182, v253, v132 op_sel:[0,1,0] op_sel_hi:[1,1,1]
v_pk_fma_f16 v58, v54, v125, v23 op_sel:[0,0,0] op_sel_hi:[1,0,1]
v_pk_fma_f16 v186, v182, v253, v133 op_sel:[0,0,0] op_sel_hi:[1,0,1]
v_pk_mul_f16 v22, v35, v125 op_sel:[0,0] op_sel_hi:[1,0]
v_pk_mul_f16 v132, v163, v253 op_sel:[0,0] op_sel_hi:[1,0]
v_pk_mul_f16 v23, v35, v125 op_sel:[0,1] op_sel_hi:[1,1] neg_lo:[0,1] neg_hi:[0,1]
v_pk_mul_f16 v133, v163, v253 op_sel:[0,1] op_sel_hi:[1,1] neg_lo:[0,1] neg_hi:[0,1]
v_pk_fma_f16 v39, v55, v125, v22 op_sel:[0,1,0] op_sel_hi:[1,1,1]
v_pk_fma_f16 v167, v183, v253, v132 op_sel:[0,1,0] op_sel_hi:[1,1,1]
v_pk_fma_f16 v59, v55, v125, v23 op_sel:[0,0,0] op_sel_hi:[1,0,1]
v_pk_fma_f16 v187, v183, v253, v133 op_sel:[0,0,0] op_sel_hi:[1,0,1]
v_pk_mul_f16 v22, v40, v121 op_sel:[0,0] op_sel_hi:[1,0]
v_pk_mul_f16 v132, v168, v249 op_sel:[0,0] op_sel_hi:[1,0]
v_pk_mul_f16 v23, v40, v121 op_sel:[0,1] op_sel_hi:[1,1] neg_lo:[0,1] neg_hi:[0,1]
v_pk_mul_f16 v133, v168, v249 op_sel:[0,1] op_sel_hi:[1,1] neg_lo:[0,1] neg_hi:[0,1]
v_pk_fma_f16 v41, v60, v121, v22 op_sel:[0,1,0] op_sel_hi:[1,1,1]
v_pk_fma_f16 v169, v188, v249, v132 op_sel:[0,1,0] op_sel_hi:[1,1,1]
v_pk_fma_f16 v61, v60, v121, v23 op_sel:[0,0,0] op_sel_hi:[1,0,1]
v_pk_fma_f16 v189, v188, v249, v133 op_sel:[0,0,0] op_sel_hi:[1,0,1]
v_pk_mul_f16 v22, v40, v125 op_sel:[0,0] op_sel_hi:[1,0]
v_pk_mul_f16 v132, v168, v253 op_sel:[0,0] op_sel_hi:[1,0]
v_pk_mul_f16 v23, v40, v125 op_sel:[0,1] op_sel_hi:[1,1] neg_lo:[0,1] neg_hi:[0,1]
v_pk_mul_f16 v133, v168, v253 op_sel:[0,1] op_sel_hi:[1,1] neg_lo:[0,1] neg_hi:[0,1]
v_pk_fma_f16 v42, v60, v125, v22 op_sel:[0,1,0] op_sel_hi:[1,1,1]
v_pk_fma_f16 v170, v188, v253, v132 op_sel:[0,1,0] op_sel_hi:[1,1,1]
v_pk_fma_f16 v62, v60, v125, v23 op_sel:[0,0,0] op_sel_hi:[1,0,1]
v_pk_fma_f16 v190, v188, v253, v133 op_sel:[0,0,0] op_sel_hi:[1,0,1]
v_pk_mul_f16 v22, v41, v125 op_sel:[0,0] op_sel_hi:[1,0]
v_pk_mul_f16 v132, v169, v253 op_sel:[0,0] op_sel_hi:[1,0]
v_pk_mul_f16 v23, v41, v125 op_sel:[0,1] op_sel_hi:[1,1] neg_lo:[0,1] neg_hi:[0,1]
v_pk_mul_f16 v133, v169, v253 op_sel:[0,1] op_sel_hi:[1,1] neg_lo:[0,1] neg_hi:[0,1]
v_pk_fma_f16 v43, v61, v125, v22 op_sel:[0,1,0] op_sel_hi:[1,1,1]
v_pk_fma_f16 v171, v189, v253, v132 op_sel:[0,1,0] op_sel_hi:[1,1,1]
v_pk_fma_f16 v63, v61, v125, v23 op_sel:[0,0,0] op_sel_hi:[1,0,1]
v_pk_fma_f16 v191, v189, v253, v133 op_sel:[0,0,0] op_sel_hi:[1,0,1]
v_pk_mul_f16 v22, v44, v125 op_sel:[0,0] op_sel_hi:[1,0]
v_pk_mul_f16 v132, v172, v253 op_sel:[0,0] op_sel_hi:[1,0]
v_pk_mul_f16 v23, v44, v125 op_sel:[0,1] op_sel_hi:[1,1] neg_lo:[0,1] neg_hi:[0,1]
v_pk_mul_f16 v133, v172, v253 op_sel:[0,1] op_sel_hi:[1,1] neg_lo:[0,1] neg_hi:[0,1]
v_pk_fma_f16 v45, v64, v125, v22 op_sel:[0,1,0] op_sel_hi:[1,1,1]
v_pk_fma_f16 v173, v192, v253, v132 op_sel:[0,1,0] op_sel_hi:[1,1,1]
v_pk_fma_f16 v65, v64, v125, v23 op_sel:[0,0,0] op_sel_hi:[1,0,1]
v_pk_fma_f16 v193, v192, v253, v133 op_sel:[0,0,0] op_sel_hi:[1,0,1]
v_pk_mul_f16 v22, v44, v126 op_sel:[0,0] op_sel_hi:[1,0]
v_pk_mul_f16 v132, v172, v254 op_sel:[0,0] op_sel_hi:[1,0]
v_pk_mul_f16 v23, v44, v126 op_sel:[0,1] op_sel_hi:[1,1] neg_lo:[0,1] neg_hi:[0,1]
v_pk_mul_f16 v133, v172, v254 op_sel:[0,1] op_sel_hi:[1,1] neg_lo:[0,1] neg_hi:[0,1]
v_pk_fma_f16 v46, v64, v126, v22 op_sel:[0,1,0] op_sel_hi:[1,1,1]
v_pk_fma_f16 v174, v192, v254, v132 op_sel:[0,1,0] op_sel_hi:[1,1,1]
v_pk_fma_f16 v66, v64, v126, v23 op_sel:[0,0,0] op_sel_hi:[1,0,1]
v_pk_fma_f16 v194, v192, v254, v133 op_sel:[0,0,0] op_sel_hi:[1,0,1]
v_pk_mul_f16 v22, v45, v126 op_sel:[0,0] op_sel_hi:[1,0]
v_pk_mul_f16 v132, v173, v254 op_sel:[0,0] op_sel_hi:[1,0]
v_pk_mul_f16 v23, v45, v126 op_sel:[0,1] op_sel_hi:[1,1] neg_lo:[0,1] neg_hi:[0,1]
v_pk_mul_f16 v133, v173, v254 op_sel:[0,1] op_sel_hi:[1,1] neg_lo:[0,1] neg_hi:[0,1]
v_pk_fma_f16 v47, v65, v126, v22 op_sel:[0,1,0] op_sel_hi:[1,1,1]
v_pk_fma_f16 v175, v193, v254, v132 op_sel:[0,1,0] op_sel_hi:[1,1,1]
v_pk_fma_f16 v67, v65, v126, v23 op_sel:[0,0,0] op_sel_hi:[1,0,1]
v_pk_fma_f16 v195, v193, v254, v133 op_sel:[0,0,0] op_sel_hi:[1,0,1]
v_pk_mul_f16 v22, v48, v126 op_sel:[0,0] op_sel_hi:[1,0]
v_pk_mul_f16 v132, v176, v254 op_sel:[0,0] op_sel_hi:[1,0]
v_pk_mul_f16 v23, v48, v126 op_sel:[0,1] op_sel_hi:[1,1] neg_lo:[0,1] neg_hi:[0,1]
v_pk_mul_f16 v133, v176, v254 op_sel:[0,1] op_sel_hi:[1,1] neg_lo:[0,1] neg_hi:[0,1]
v_pk_fma_f16 v49, v68, v126, v22 op_sel:[0,1,0] op_sel_hi:[1,1,1]
v_pk_fma_f16 v177, v196, v254, v132 op_sel:[0,1,0] op_sel_hi:[1,1,1]
v_pk_fma_f16 v69, v68, v126, v23 op_sel:[0,0,0] op_sel_hi:[1,0,1]
v_pk_fma_f16 v197, v196, v254, v133 op_sel:[0,0,0] op_sel_hi:[1,0,1]
v_pk_mul_f16 v22, v48, v127 op_sel:[0,0] op_sel_hi:[1,0]
v_pk_mul_f16 v132, v176, v255 op_sel:[0,0] op_sel_hi:[1,0]
v_pk_mul_f16 v23, v48, v127 op_sel:[0,1] op_sel_hi:[1,1] neg_lo:[0,1] neg_hi:[0,1]
v_pk_mul_f16 v133, v176, v255 op_sel:[0,1] op_sel_hi:[1,1] neg_lo:[0,1] neg_hi:[0,1]
v_pk_fma_f16 v50, v68, v127, v22 op_sel:[0,1,0] op_sel_hi:[1,1,1]
v_pk_fma_f16 v178, v196, v255, v132 op_sel:[0,1,0] op_sel_hi:[1,1,1]
v_pk_fma_f16 v70, v68, v127, v23 op_sel:[0,0,0] op_sel_hi:[1,0,1]
v_pk_fma_f16 v198, v196, v255, v133 op_sel:[0,0,0] op_sel_hi:[1,0,1]
v_pk_mul_f16 v22, v49, v127 op_sel:[0,0] op_sel_hi:[1,0]
v_pk_mul_f16 v132, v177, v255 op_sel:[0,0] op_sel_hi:[1,0]
v_pk_mul_f16 v23, v49, v127 op_sel:[0,1] op_sel_hi:[1,1] neg_lo:[0,1] neg_hi:[0,1]
v_pk_mul_f16 v133, v177, v255 op_sel:[0,1] op_sel_hi:[1,1] neg_lo:[0,1] neg_hi:[0,1]
v_pk_fma_f16 v51, v69, v127, v22 op_sel:[0,1,0] op_sel_hi:[1,1,1]
v_pk_fma_f16 v179, v197, v255, v132 op_sel:[0,1,0] op_sel_hi:[1,1,1]
v_pk_fma_f16 v71, v69, v127, v23 op_sel:[0,0,0] op_sel_hi:[1,0,1]
v_pk_fma_f16 v199, v197, v255, v133 op_sel:[0,0,0] op_sel_hi:[1,0,1]
ds_write_b128 v128, v[32:35] offset:0
ds_write_b128 v128, v[36:39] offset:16
ds_write_b128 v128, v[40:43] offset:32
ds_write_b128 v128, v[44:47] offset:48
ds_write_b128 v128, v[48:51] offset:64
ds_write_b128 v128, v[52:55] offset:80
ds_write_b128 v128, v[56:59] offset:96
ds_write_b128 v128, v[60:63] offset:112
ds_write_b128 v128, v[64:67] offset:128
ds_write_b128 v128, v[68:71] offset:144
ds_write_b128 v128, v[72:75] offset:160
ds_write_b128 v128, v[76:79] offset:176
ds_write_b128 v128, v[80:83] offset:192
ds_write_b128 v128, v[84:87] offset:208
ds_read_b64_tr_b16 v[224:225], v129 offset:0
ds_read_b64_tr_b16 v[226:227], v129 offset:240
ds_read_b64_tr_b16 v[228:229], v129 offset:32
ds_read_b64_tr_b16 v[230:231], v129 offset:272
ds_read_b64_tr_b16 v[232:233], v129 offset:64
ds_read_b64_tr_b16 v[234:235], v129 offset:304
ds_read_b64_tr_b16 v[236:237], v129 offset:160
ds_read_b64_tr_b16 v[238:239], v129 offset:400
ds_read_b64_tr_b16 v[240:241], v129 offset:80
ds_read_b64_tr_b16 v[242:243], v129 offset:320
ds_read_b64_tr_b16 v[244:245], v129 offset:112
ds_read_b64_tr_b16 v[246:247], v129 offset:352
ds_read_b64_tr_b16 v[248:249], v129 offset:144
ds_read_b64_tr_b16 v[250:251], v129 offset:384
ds_read_b64_tr_b16 v[252:253], v129 offset:192
ds_read_b64_tr_b16 v[254:255], v129 offset:432
s_waitcnt lgkmcnt(8)
v_mfma_f32_16x16x32_f16 v[148:151], v[224:227], v[236:239], 0
v_mfma_f32_16x16x32_f16 v[152:155], v[228:231], v[236:239], 0
v_mfma_f32_16x16x32_f16 v[156:159], v[232:235], v[236:239], 0
ds_read_b64_tr_b16 v[224:225], v129 offset:7680
ds_read_b64_tr_b16 v[226:227], v129 offset:7920
ds_read_b64_tr_b16 v[228:229], v129 offset:7712
ds_read_b64_tr_b16 v[230:231], v129 offset:7952
ds_read_b64_tr_b16 v[232:233], v129 offset:7744
ds_read_b64_tr_b16 v[234:235], v129 offset:7984
ds_read_b64_tr_b16 v[236:237], v129 offset:7840
ds_read_b64_tr_b16 v[238:239], v129 offset:8080
s_waitcnt lgkmcnt(8)
v_mfma_f32_16x16x32_f16 v[148:151], v[240:243], v[252:255], v[148:151]
v_mfma_f32_16x16x32_f16 v[152:155], v[244:247], v[252:255], v[152:155]
v_mfma_f32_16x16x32_f16 v[156:159], v[248:251], v[252:255], v[156:159]
ds_read_b64_tr_b16 v[240:241], v129 offset:7760
ds_read_b64_tr_b16 v[242:243], v129 offset:8000
ds_read_b64_tr_b16 v[244:245], v129 offset:7792
ds_read_b64_tr_b16 v[246:247], v129 offset:8032
ds_read_b64_tr_b16 v[248:249], v129 offset:7824
ds_read_b64_tr_b16 v[250:251], v129 offset:8064
ds_read_b64_tr_b16 v[252:253], v129 offset:7872
ds_read_b64_tr_b16 v[254:255], v129 offset:8112
s_waitcnt lgkmcnt(8)
v_mfma_f32_16x16x32_f16 v[148:151], v[224:227], v[236:239], v[148:151]
v_mfma_f32_16x16x32_f16 v[152:155], v[228:231], v[236:239], v[152:155]
v_mfma_f32_16x16x32_f16 v[156:159], v[232:235], v[236:239], v[156:159]
s_waitcnt lgkmcnt(0)
v_mfma_f32_16x16x32_f16 v[148:151], v[240:243], v[252:255], v[148:151]
v_mfma_f32_16x16x32_f16 v[152:155], v[244:247], v[252:255], v[152:155]
v_mfma_f32_16x16x32_f16 v[156:159], v[248:251], v[252:255], v[156:159]
ds_write_b128 v128, v[160:163] offset:0
ds_write_b128 v128, v[164:167] offset:16
ds_write_b128 v128, v[168:171] offset:32
ds_write_b128 v128, v[172:175] offset:48
ds_write_b128 v128, v[176:179] offset:64
ds_write_b128 v128, v[180:183] offset:80
ds_write_b128 v128, v[184:187] offset:96
ds_write_b128 v128, v[188:191] offset:112
ds_write_b128 v128, v[192:195] offset:128
ds_write_b128 v128, v[196:199] offset:144
ds_write_b128 v128, v[200:203] offset:160
ds_write_b128 v128, v[204:207] offset:176
ds_write_b128 v128, v[208:211] offset:192
ds_write_b128 v128, v[212:215] offset:208
v_add_f32 v144, v144, v145
ds_read_b64_tr_b16 v[224:225], v129 offset:0
ds_read_b64_tr_b16 v[226:227], v129 offset:240
ds_read_b64_tr_b16 v[228:229], v129 offset:32
ds_read_b64_tr_b16 v[230:231], v129 offset:272
ds_read_b64_tr_b16 v[232:233], v129 offset:64
ds_read_b64_tr_b16 v[234:235], v129 offset:304
ds_read_b64_tr_b16 v[236:237], v129 offset:160
ds_read_b64_tr_b16 v[238:239], v129 offset:400
ds_read_b64_tr_b16 v[240:241], v129 offset:80
ds_read_b64_tr_b16 v[242:243], v129 offset:320
ds_read_b64_tr_b16 v[244:245], v129 offset:112
ds_read_b64_tr_b16 v[246:247], v129 offset:352
ds_read_b64_tr_b16 v[248:249], v129 offset:144
ds_read_b64_tr_b16 v[250:251], v129 offset:384
ds_read_b64_tr_b16 v[252:253], v129 offset:192
ds_read_b64_tr_b16 v[254:255], v129 offset:432
s_waitcnt lgkmcnt(8)
v_mfma_f32_16x16x32_f16 v[148:151], v[224:227], v[236:239], v[148:151]
v_mfma_f32_16x16x32_f16 v[152:155], v[228:231], v[236:239], v[152:155]
v_mfma_f32_16x16x32_f16 v[156:159], v[232:235], v[236:239], v[156:159]
ds_read_b64_tr_b16 v[224:225], v129 offset:7680
ds_read_b64_tr_b16 v[226:227], v129 offset:7920
ds_read_b64_tr_b16 v[228:229], v129 offset:7712
ds_read_b64_tr_b16 v[230:231], v129 offset:7952
ds_read_b64_tr_b16 v[232:233], v129 offset:7744
ds_read_b64_tr_b16 v[234:235], v129 offset:7984
ds_read_b64_tr_b16 v[236:237], v129 offset:7840
ds_read_b64_tr_b16 v[238:239], v129 offset:8080
s_waitcnt lgkmcnt(8)
v_mfma_f32_16x16x32_f16 v[148:151], v[240:243], v[252:255], v[148:151]
v_mfma_f32_16x16x32_f16 v[152:155], v[244:247], v[252:255], v[152:155]
v_mfma_f32_16x16x32_f16 v[156:159], v[248:251], v[252:255], v[156:159]
ds_read_b64_tr_b16 v[240:241], v129 offset:7760
ds_read_b64_tr_b16 v[242:243], v129 offset:8000
ds_read_b64_tr_b16 v[244:245], v129 offset:7792
ds_read_b64_tr_b16 v[246:247], v129 offset:8032
ds_read_b64_tr_b16 v[248:249], v129 offset:7824
ds_read_b64_tr_b16 v[250:251], v129 offset:8064
ds_read_b64_tr_b16 v[252:253], v129 offset:7872
ds_read_b64_tr_b16 v[254:255], v129 offset:8112
s_waitcnt lgkmcnt(8)
v_mfma_f32_16x16x32_f16 v[148:151], v[224:227], v[236:239], v[148:151]
v_mfma_f32_16x16x32_f16 v[152:155], v[228:231], v[236:239], v[152:155]
v_mfma_f32_16x16x32_f16 v[156:159], v[232:235], v[236:239], v[156:159]
s_waitcnt lgkmcnt(0)
v_mfma_f32_16x16x32_f16 v[148:151], v[240:243], v[252:255], v[148:151]
v_mfma_f32_16x16x32_f16 v[152:155], v[244:247], v[252:255], v[152:155]
v_mfma_f32_16x16x32_f16 v[156:159], v[248:251], v[252:255], v[156:159]
v_add_f32_dpp v144, v144, v144 row_ror:8 row_mask:0xf bank_mask:0xf
s_nop 1
v_add_f32_dpp v144, v144, v144 row_ror:4 row_mask:0xf bank_mask:0xf
s_nop 1
v_add_f32_dpp v144, v144, v144 row_ror:2 row_mask:0xf bank_mask:0xf
s_nop 1
v_add_f32_dpp v144, v144, v144 row_ror:1 row_mask:0xf bank_mask:0xf
s_nop 0
v_readlane_b32 s96, v144, 0
v_readlane_b32 s97, v144, 16
v_readlane_b32 s98, v144, 32
v_readlane_b32 s99, v144, 48
v_mov_b32 v145, s96
v_add_f32 v145, s97, v145
v_add_f32 v145, s98, v145
v_add_f32 v145, s99, v145
v_mul_f32 v148, v19, v148
v_mul_f32 v149, v19, v149
v_mul_f32 v150, v19, v150
v_mul_f32 v151, v19, v151
v_mul_f32 v152, v19, v152
v_mul_f32 v153, v19, v153
v_mul_f32 v154, v19, v154
v_mul_f32 v155, v19, v155
v_mul_f32 v156, v19, v156
v_mul_f32 v157, v19, v157
v_mul_f32 v158, v19, v158
v_mul_f32 v159, v19, v159
v_mul_f32 v145, v19, v145
v_cmp_eq_u32 vcc, 0, v2
v_add_f32 v20, v17, v148
s_nop 0
v_cndmask_b32 v148, v148, v20, vcc
v_cmp_eq_u32 vcc, 32, v2
s_nop 1
v_cndmask_b32 v156, v156, v145, vcc
s_add_u32 s48, s46, 0x1400000
s_addc_u32 s49, s47, 0
s_mov_b32 s50, 0x1e0000
s_mov_b32 s51, 0x20000
s_mul_i32 s12, s4, 3072
buffer_store_dwordx4 v[148:151], v7, s[48:51], s12 offen offset:0 sc1
buffer_store_dwordx4 v[152:155], v7, s[48:51], s12 offen offset:1024 sc1
buffer_store_dwordx4 v[156:159], v7, s[48:51], s12 offen offset:2048 sc1
s_and_b32 s4, s2, 7
s_lshr_b32 s5, s2, 3
s_mul_i32 s6, s5, 37
s_lshr_b32 s6, s6, 8
s_mul_i32 s7, s6, 7
s_sub_u32 s5, s5, s7
s_add_u32 s3, s5, s6
s_and_b32 s7, s4, 1
s_mul_i32 s7, s7, 7
s_add_u32 s5, s5, s7
s_lshr_b32 s4, s4, 1
s_lshl_b32 s4, s4, 2
s_add_u32 s4, s4, s6
s_mov_b32 s60, s46
s_mov_b32 s61, s47
s_mov_b32 s62, 0x6c0000
s_mov_b32 s63, 0x20000
s_branch G1NK_3e
G1NK_3b:
buffer_load_dwordx2 v[216:217], v5, s[56:59], 0 offen offset:0
buffer_load_dwordx2 v[218:219], v5, s[56:59], 0 offen offset:32
buffer_load_dwordx2 v[220:221], v5, s[56:59], 0 offen offset:64
buffer_load_dwordx2 v[222:223], v5, s[56:59], 0 offen offset:96
s_waitcnt vmcnt(0)
G1NK_3e:
s_lshr_b32 s15, s8, 1
s_and_b32 s16, s8, 1
s_lshl_b32 s11, s5, 8
v_lshrrev_b32 v6, 1, v3
v_xor_b32 v6, v6, v4
s_lshl_b32 s10, s16, 6
v_add_u32 v5, s10, v3
v_lshlrev_b32 v5, 7, v5
v_lshl_add_u32 v14, v6, 4, v5
v_xor_b32 v6, 4, v6
v_lshl_add_u32 v17, v6, 4, v5
v_bfe_u32 v5, v2, 2, 2
v_and_b32 v6, 3, v2
v_lshlrev_b32 v7, 11, v4
v_lshl_add_u32 v7, v5, 6, v7
v_lshl_add_u32 v7, v6, 3, v7
s_lshl_b32 s10, s15, 9
s_add_u32 s10, s10, 81920
v_add_u32 v7, s10, v7
v_and_b32 v8, 1, v4
v_lshl_add_u32 v15, v8, 5, v7
v_xor_b32 v8, 1, v8
v_lshl_add_u32 v16, v8, 5, v7
v_lshlrev_b32 v13, 4, v2
v_add_u32 v18, 49152, v14
v_add_u32 v19, 49152, v17
v_add_u32 v22, 49152, v15
v_add_u32 v23, 49152, v16
v_lshlrev_b32 v152, 16, v216
v_and_b32 v153, 0xffff0000, v216
v_lshlrev_b32 v154, 16, v217
v_and_b32 v155, 0xffff0000, v217
v_lshlrev_b32 v156, 16, v218
v_and_b32 v157, 0xffff0000, v218
v_lshlrev_b32 v158, 16, v219
v_and_b32 v159, 0xffff0000, v219
v_lshlrev_b32 v160, 16, v220
v_and_b32 v161, 0xffff0000, v220
v_lshlrev_b32 v162, 16, v221
v_and_b32 v163, 0xffff0000, v221
v_lshlrev_b32 v164, 16, v222
v_and_b32 v165, 0xffff0000, v222
v_lshlrev_b32 v166, 16, v223
v_and_b32 v167, 0xffff0000, v223
s_lshl_b32 s10, s5, 1
s_add_u32 s10, s10, s15
s_cmp_eq_u32 s10, 27
s_cbranch_scc1 G1G_4
s_barrier
ds_read_b64_tr_b16 v[104:105], v15 offset:0
ds_read_b64_tr_b16 v[106:107], v15 offset:1024
ds_read_b128 v[88:91], v14 offset:0
ds_read_b64_tr_b16 v[108:109], v16 offset:0
ds_read_b64_tr_b16 v[110:111], v16 offset:1024
ds_read_b128 v[92:95], v14 offset:2048
ds_read_b64_tr_b16 v[112:113], v15 offset:256
ds_read_b64_tr_b16 v[114:115], v15 offset:1280
ds_read_b128 v[96:99], v14 offset:4096
ds_read_b64_tr_b16 v[116:117], v16 offset:256
ds_read_b64_tr_b16 v[118:119], v16 offset:1280
ds_read_b128 v[100:103], v14 offset:6144
s_waitcnt lgkmcnt(0)
s_barrier
v_mfma_f32_16x16x32_bf16 v[24:27], v[104:107], v[88:91], v[152:155]
ds_read_b64_tr_b16 v[136:137], v15 offset:8192
v_mfma_f32_16x16x32_bf16 v[28:31], v[104:107], v[92:95], v[152:155]
ds_read_b64_tr_b16 v[138:139], v15 offset:9216
v_mfma_f32_16x16x32_bf16 v[32:35], v[104:107], v[96:99], v[152:155]
ds_read_b128 v[120:123], v17 offset:0
v_mfma_f32_16x16x32_bf16 v[36:39], v[104:107], v[100:103], v[152:155]
ds_read_b64_tr_b16 v[140:141], v16 offset:8192
v_mfma_f32_16x16x32_bf16 v[40:43], v[108:111], v[88:91], v[156:159]
ds_read_b64_tr_b16 v[142:143], v16 offset:9216
v_mfma_f32_16x16x32_bf16 v[44:47], v[108:111], v[92:95], v[156:159]
ds_read_b128 v[124:127], v17 offset:2048
v_mfma_f32_16x16x32_bf16 v[48:51], v[108:111], v[96:99], v[156:159]
ds_read_b64_tr_b16 v[144:145], v15 offset:8448
v_mfma_f32_16x16x32_bf16 v[52:55], v[108:111], v[100:103], v[156:159]
ds_read_b64_tr_b16 v[146:147], v15 offset:9472
v_mfma_f32_16x16x32_bf16 v[56:59], v[112:115], v[88:91], v[160:163]
ds_read_b128 v[128:131], v17 offset:4096
v_mfma_f32_16x16x32_bf16 v[60:63], v[112:115], v[92:95], v[160:163]
ds_read_b64_tr_b16 v[148:149], v16 offset:8448
v_mfma_f32_16x16x32_bf16 v[64:67], v[112:115], v[96:99], v[160:163]
ds_read_b64_tr_b16 v[150:151], v16 offset:9472
v_mfma_f32_16x16x32_bf16 v[68:71], v[112:115], v[100:103], v[160:163]
ds_read_b128 v[132:135], v17 offset:6144
v_mfma_f32_16x16x32_bf16 v[72:75], v[116:119], v[88:91], v[164:167]
v_mfma_f32_16x16x32_bf16 v[76:79], v[116:119], v[92:95], v[164:167]
v_mfma_f32_16x16x32_bf16 v[80:83], v[116:119], v[96:99], v[164:167]
v_mfma_f32_16x16x32_bf16 v[84:87], v[116:119], v[100:103], v[164:167]
s_waitcnt lgkmcnt(0)
s_barrier
v_mfma_f32_16x16x32_bf16 v[24:27], v[136:139], v[120:123], v[24:27]
ds_read_b64_tr_b16 v[104:105], v15 offset:16384
v_mfma_f32_16x16x32_bf16 v[28:31], v[136:139], v[124:127], v[28:31]
ds_read_b64_tr_b16 v[106:107], v15 offset:17408
v_mfma_f32_16x16x32_bf16 v[32:35], v[136:139], v[128:131], v[32:35]
ds_read_b128 v[88:91], v14 offset:16384
v_mfma_f32_16x16x32_bf16 v[36:39], v[136:139], v[132:135], v[36:39]
ds_read_b64_tr_b16 v[108:109], v16 offset:16384
v_mfma_f32_16x16x32_bf16 v[40:43], v[140:143], v[120:123], v[40:43]
ds_read_b64_tr_b16 v[110:111], v16 offset:17408
v_mfma_f32_16x16x32_bf16 v[44:47], v[140:143], v[124:127], v[44:47]
ds_read_b128 v[92:95], v14 offset:18432
v_mfma_f32_16x16x32_bf16 v[48:51], v[140:143], v[128:131], v[48:51]
ds_read_b64_tr_b16 v[112:113], v15 offset:16640
v_mfma_f32_16x16x32_bf16 v[52:55], v[140:143], v[132:135], v[52:55]
ds_read_b64_tr_b16 v[114:115], v15 offset:17664
v_mfma_f32_16x16x32_bf16 v[56:59], v[144:147], v[120:123], v[56:59]
ds_read_b128 v[96:99], v14 offset:20480
v_mfma_f32_16x16x32_bf16 v[60:63], v[144:147], v[124:127], v[60:63]
ds_read_b64_tr_b16 v[116:117], v16 offset:16640
v_mfma_f32_16x16x32_bf16 v[64:67], v[144:147], v[128:131], v[64:67]
ds_read_b64_tr_b16 v[118:119], v16 offset:17664
v_mfma_f32_16x16x32_bf16 v[68:71], v[144:147], v[132:135], v[68:71]
ds_read_b128 v[100:103], v14 offset:22528
v_mfma_f32_16x16x32_bf16 v[72:75], v[148:151], v[120:123], v[72:75]
v_mfma_f32_16x16x32_bf16 v[76:79], v[148:151], v[124:127], v[76:79]
v_mfma_f32_16x16x32_bf16 v[80:83], v[148:151], v[128:131], v[80:83]
v_mfma_f32_16x16x32_bf16 v[84:87], v[148:151], v[132:135], v[84:87]
s_waitcnt lgkmcnt(0)
s_barrier
v_mfma_f32_16x16x32_bf16 v[24:27], v[104:107], v[88:91], v[24:27]
ds_read_b64_tr_b16 v[136:137], v15 offset:24576
v_mfma_f32_16x16x32_bf16 v[28:31], v[104:107], v[92:95], v[28:31]
ds_read_b64_tr_b16 v[138:139], v15 offset:25600
v_mfma_f32_16x16x32_bf16 v[32:35], v[104:107], v[96:99], v[32:35]
ds_read_b128 v[120:123], v17 offset:16384
v_mfma_f32_16x16x32_bf16 v[36:39], v[104:107], v[100:103], v[36:39]
ds_read_b64_tr_b16 v[140:141], v16 offset:24576
v_mfma_f32_16x16x32_bf16 v[40:43], v[108:111], v[88:91], v[40:43]
ds_read_b64_tr_b16 v[142:143], v16 offset:25600
v_mfma_f32_16x16x32_bf16 v[44:47], v[108:111], v[92:95], v[44:47]
ds_read_b128 v[124:127], v17 offset:18432
v_mfma_f32_16x16x32_bf16 v[48:51], v[108:111], v[96:99], v[48:51]
ds_read_b64_tr_b16 v[144:145], v15 offset:24832
v_mfma_f32_16x16x32_bf16 v[52:55], v[108:111], v[100:103], v[52:55]
ds_read_b64_tr_b16 v[146:147], v15 offset:25856
v_mfma_f32_16x16x32_bf16 v[56:59], v[112:115], v[88:91], v[56:59]
ds_read_b128 v[128:131], v17 offset:20480
v_mfma_f32_16x16x32_bf16 v[60:63], v[112:115], v[92:95], v[60:63]
ds_read_b64_tr_b16 v[148:149], v16 offset:24832
v_mfma_f32_16x16x32_bf16 v[64:67], v[112:115], v[96:99], v[64:67]
ds_read_b64_tr_b16 v[150:151], v16 offset:25856
v_mfma_f32_16x16x32_bf16 v[68:71], v[112:115], v[100:103], v[68:71]
ds_read_b128 v[132:135], v17 offset:22528
v_mfma_f32_16x16x32_bf16 v[72:75], v[116:119], v[88:91], v[72:75]
v_mfma_f32_16x16x32_bf16 v[76:79], v[116:119], v[92:95], v[76:79]
v_mfma_f32_16x16x32_bf16 v[80:83], v[116:119], v[96:99], v[80:83]
v_mfma_f32_16x16x32_bf16 v[84:87], v[116:119], v[100:103], v[84:87]
s_waitcnt lgkmcnt(0)
s_barrier
v_mfma_f32_16x16x32_bf16 v[24:27], v[136:139], v[120:123], v[24:27]
ds_read_b64_tr_b16 v[104:105], v15 offset:32768
v_mfma_f32_16x16x32_bf16 v[28:31], v[136:139], v[124:127], v[28:31]
ds_read_b64_tr_b16 v[106:107], v15 offset:33792
v_mfma_f32_16x16x32_bf16 v[32:35], v[136:139], v[128:131], v[32:35]
ds_read_b128 v[88:91], v14 offset:32768
v_mfma_f32_16x16x32_bf16 v[36:39], v[136:139], v[132:135], v[36:39]
ds_read_b64_tr_b16 v[108:109], v16 offset:32768
v_mfma_f32_16x16x32_bf16 v[40:43], v[140:143], v[120:123], v[40:43]
ds_read_b64_tr_b16 v[110:111], v16 offset:33792
v_mfma_f32_16x16x32_bf16 v[44:47], v[140:143], v[124:127], v[44:47]
ds_read_b128 v[92:95], v14 offset:34816
v_mfma_f32_16x16x32_bf16 v[48:51], v[140:143], v[128:131], v[48:51]
ds_read_b64_tr_b16 v[112:113], v15 offset:33024
v_mfma_f32_16x16x32_bf16 v[52:55], v[140:143], v[132:135], v[52:55]
ds_read_b64_tr_b16 v[114:115], v15 offset:34048
v_mfma_f32_16x16x32_bf16 v[56:59], v[144:147], v[120:123], v[56:59]
ds_read_b128 v[96:99], v14 offset:36864
v_mfma_f32_16x16x32_bf16 v[60:63], v[144:147], v[124:127], v[60:63]
ds_read_b64_tr_b16 v[116:117], v16 offset:33024
v_mfma_f32_16x16x32_bf16 v[64:67], v[144:147], v[128:131], v[64:67]
ds_read_b64_tr_b16 v[118:119], v16 offset:34048
v_mfma_f32_16x16x32_bf16 v[68:71], v[144:147], v[132:135], v[68:71]
ds_read_b128 v[100:103], v14 offset:38912
v_mfma_f32_16x16x32_bf16 v[72:75], v[148:151], v[120:123], v[72:75]
v_mfma_f32_16x16x32_bf16 v[76:79], v[148:151], v[124:127], v[76:79]
v_mfma_f32_16x16x32_bf16 v[80:83], v[148:151], v[128:131], v[80:83]
v_mfma_f32_16x16x32_bf16 v[84:87], v[148:151], v[132:135], v[84:87]
s_waitcnt lgkmcnt(0)
s_barrier
v_mfma_f32_16x16x32_bf16 v[24:27], v[104:107], v[88:91], v[24:27]
ds_read_b64_tr_b16 v[136:137], v15 offset:40960
v_mfma_f32_16x16x32_bf16 v[28:31], v[104:107], v[92:95], v[28:31]
ds_read_b64_tr_b16 v[138:139], v15 offset:41984
v_mfma_f32_16x16x32_bf16 v[32:35], v[104:107], v[96:99], v[32:35]
ds_read_b128 v[120:123], v17 offset:32768
v_mfma_f32_16x16x32_bf16 v[36:39], v[104:107], v[100:103], v[36:39]
ds_read_b64_tr_b16 v[140:141], v16 offset:40960
v_mfma_f32_16x16x32_bf16 v[40:43], v[108:111], v[88:91], v[40:43]
ds_read_b64_tr_b16 v[142:143], v16 offset:41984
v_mfma_f32_16x16x32_bf16 v[44:47], v[108:111], v[92:95], v[44:47]
ds_read_b128 v[124:127], v17 offset:34816
v_mfma_f32_16x16x32_bf16 v[48:51], v[108:111], v[96:99], v[48:51]
ds_read_b64_tr_b16 v[144:145], v15 offset:41216
v_mfma_f32_16x16x32_bf16 v[52:55], v[108:111], v[100:103], v[52:55]
ds_read_b64_tr_b16 v[146:147], v15 offset:42240
v_mfma_f32_16x16x32_bf16 v[56:59], v[112:115], v[88:91], v[56:59]
ds_read_b128 v[128:131], v17 offset:36864
v_mfma_f32_16x16x32_bf16 v[60:63], v[112:115], v[92:95], v[60:63]
ds_read_b64_tr_b16 v[148:149], v16 offset:41216
v_mfma_f32_16x16x32_bf16 v[64:67], v[112:115], v[96:99], v[64:67]
ds_read_b64_tr_b16 v[150:151], v16 offset:42240
v_mfma_f32_16x16x32_bf16 v[68:71], v[112:115], v[100:103], v[68:71]
ds_read_b128 v[132:135], v17 offset:38912
v_mfma_f32_16x16x32_bf16 v[72:75], v[116:119], v[88:91], v[72:75]
v_mfma_f32_16x16x32_bf16 v[76:79], v[116:119], v[92:95], v[76:79]
v_mfma_f32_16x16x32_bf16 v[80:83], v[116:119], v[96:99], v[80:83]
v_mfma_f32_16x16x32_bf16 v[84:87], v[116:119], v[100:103], v[84:87]
s_waitcnt lgkmcnt(0)
s_barrier
v_mfma_f32_16x16x32_bf16 v[24:27], v[136:139], v[120:123], v[24:27]
ds_read_b64_tr_b16 v[104:105], v22 offset:0
v_mfma_f32_16x16x32_bf16 v[28:31], v[136:139], v[124:127], v[28:31]
ds_read_b64_tr_b16 v[106:107], v22 offset:1024
v_mfma_f32_16x16x32_bf16 v[32:35], v[136:139], v[128:131], v[32:35]
ds_read_b128 v[88:91], v18 offset:0
v_mfma_f32_16x16x32_bf16 v[36:39], v[136:139], v[132:135], v[36:39]
ds_read_b64_tr_b16 v[108:109], v23 offset:0
v_mfma_f32_16x16x32_bf16 v[40:43], v[140:143], v[120:123], v[40:43]
ds_read_b64_tr_b16 v[110:111], v23 offset:1024
v_mfma_f32_16x16x32_bf16 v[44:47], v[140:143], v[124:127], v[44:47]
ds_read_b128 v[92:95], v18 offset:2048
v_mfma_f32_16x16x32_bf16 v[48:51], v[140:143], v[128:131], v[48:51]
ds_read_b64_tr_b16 v[112:113], v22 offset:256
v_mfma_f32_16x16x32_bf16 v[52:55], v[140:143], v[132:135], v[52:55]
ds_read_b64_tr_b16 v[114:115], v22 offset:1280
v_mfma_f32_16x16x32_bf16 v[56:59], v[144:147], v[120:123], v[56:59]
ds_read_b128 v[96:99], v18 offset:4096
v_mfma_f32_16x16x32_bf16 v[60:63], v[144:147], v[124:127], v[60:63]
ds_read_b64_tr_b16 v[116:117], v23 offset:256
v_mfma_f32_16x16x32_bf16 v[64:67], v[144:147], v[128:131], v[64:67]
ds_read_b64_tr_b16 v[118:119], v23 offset:1280
v_mfma_f32_16x16x32_bf16 v[68:71], v[144:147], v[132:135], v[68:71]
ds_read_b128 v[100:103], v18 offset:6144
v_mfma_f32_16x16x32_bf16 v[72:75], v[148:151], v[120:123], v[72:75]
v_mfma_f32_16x16x32_bf16 v[76:79], v[148:151], v[124:127], v[76:79]
v_mfma_f32_16x16x32_bf16 v[80:83], v[148:151], v[128:131], v[80:83]
v_mfma_f32_16x16x32_bf16 v[84:87], v[148:151], v[132:135], v[84:87]
s_waitcnt lgkmcnt(0)
s_barrier
v_mfma_f32_16x16x32_bf16 v[24:27], v[104:107], v[88:91], v[24:27]
ds_read_b64_tr_b16 v[136:137], v22 offset:8192
v_mfma_f32_16x16x32_bf16 v[28:31], v[104:107], v[92:95], v[28:31]
ds_read_b64_tr_b16 v[138:139], v22 offset:9216
v_mfma_f32_16x16x32_bf16 v[32:35], v[104:107], v[96:99], v[32:35]
ds_read_b128 v[120:123], v19 offset:0
v_mfma_f32_16x16x32_bf16 v[36:39], v[104:107], v[100:103], v[36:39]
ds_read_b64_tr_b16 v[140:141], v23 offset:8192
v_mfma_f32_16x16x32_bf16 v[40:43], v[108:111], v[88:91], v[40:43]
ds_read_b64_tr_b16 v[142:143], v23 offset:9216
v_mfma_f32_16x16x32_bf16 v[44:47], v[108:111], v[92:95], v[44:47]
ds_read_b128 v[124:127], v19 offset:2048
v_mfma_f32_16x16x32_bf16 v[48:51], v[108:111], v[96:99], v[48:51]
ds_read_b64_tr_b16 v[144:145], v22 offset:8448
v_mfma_f32_16x16x32_bf16 v[52:55], v[108:111], v[100:103], v[52:55]
ds_read_b64_tr_b16 v[146:147], v22 offset:9472
v_mfma_f32_16x16x32_bf16 v[56:59], v[112:115], v[88:91], v[56:59]
ds_read_b128 v[128:131], v19 offset:4096
v_mfma_f32_16x16x32_bf16 v[60:63], v[112:115], v[92:95], v[60:63]
ds_read_b64_tr_b16 v[148:149], v23 offset:8448
v_mfma_f32_16x16x32_bf16 v[64:67], v[112:115], v[96:99], v[64:67]
ds_read_b64_tr_b16 v[150:151], v23 offset:9472
v_mfma_f32_16x16x32_bf16 v[68:71], v[112:115], v[100:103], v[68:71]
ds_read_b128 v[132:135], v19 offset:6144
v_mfma_f32_16x16x32_bf16 v[72:75], v[116:119], v[88:91], v[72:75]
v_mfma_f32_16x16x32_bf16 v[76:79], v[116:119], v[92:95], v[76:79]
v_mfma_f32_16x16x32_bf16 v[80:83], v[116:119], v[96:99], v[80:83]
v_mfma_f32_16x16x32_bf16 v[84:87], v[116:119], v[100:103], v[84:87]
s_waitcnt lgkmcnt(0)
s_barrier
v_mfma_f32_16x16x32_bf16 v[24:27], v[136:139], v[120:123], v[24:27]
ds_read_b64_tr_b16 v[104:105], v22 offset:16384
v_mfma_f32_16x16x32_bf16 v[28:31], v[136:139], v[124:127], v[28:31]
ds_read_b64_tr_b16 v[106:107], v22 offset:17408
v_mfma_f32_16x16x32_bf16 v[32:35], v[136:139], v[128:131], v[32:35]
ds_read_b128 v[88:91], v18 offset:16384
v_mfma_f32_16x16x32_bf16 v[36:39], v[136:139], v[132:135], v[36:39]
ds_read_b64_tr_b16 v[108:109], v23 offset:16384
v_mfma_f32_16x16x32_bf16 v[40:43], v[140:143], v[120:123], v[40:43]
ds_read_b64_tr_b16 v[110:111], v23 offset:17408
v_mfma_f32_16x16x32_bf16 v[44:47], v[140:143], v[124:127], v[44:47]
ds_read_b128 v[92:95], v18 offset:18432
v_mfma_f32_16x16x32_bf16 v[48:51], v[140:143], v[128:131], v[48:51]
ds_read_b64_tr_b16 v[112:113], v22 offset:16640
v_mfma_f32_16x16x32_bf16 v[52:55], v[140:143], v[132:135], v[52:55]
ds_read_b64_tr_b16 v[114:115], v22 offset:17664
v_mfma_f32_16x16x32_bf16 v[56:59], v[144:147], v[120:123], v[56:59]
ds_read_b128 v[96:99], v18 offset:20480
v_mfma_f32_16x16x32_bf16 v[60:63], v[144:147], v[124:127], v[60:63]
ds_read_b64_tr_b16 v[116:117], v23 offset:16640
v_mfma_f32_16x16x32_bf16 v[64:67], v[144:147], v[128:131], v[64:67]
ds_read_b64_tr_b16 v[118:119], v23 offset:17664
v_mfma_f32_16x16x32_bf16 v[68:71], v[144:147], v[132:135], v[68:71]
ds_read_b128 v[100:103], v18 offset:22528
v_mfma_f32_16x16x32_bf16 v[72:75], v[148:151], v[120:123], v[72:75]
v_mfma_f32_16x16x32_bf16 v[76:79], v[148:151], v[124:127], v[76:79]
v_mfma_f32_16x16x32_bf16 v[80:83], v[148:151], v[128:131], v[80:83]
v_mfma_f32_16x16x32_bf16 v[84:87], v[148:151], v[132:135], v[84:87]
s_waitcnt lgkmcnt(0)
s_barrier
v_mfma_f32_16x16x32_bf16 v[24:27], v[104:107], v[88:91], v[24:27]
ds_read_b64_tr_b16 v[136:137], v22 offset:24576
v_mfma_f32_16x16x32_bf16 v[28:31], v[104:107], v[92:95], v[28:31]
ds_read_b64_tr_b16 v[138:139], v22 offset:25600
v_mfma_f32_16x16x32_bf16 v[32:35], v[104:107], v[96:99], v[32:35]
ds_read_b128 v[120:123], v19 offset:16384
v_mfma_f32_16x16x32_bf16 v[36:39], v[104:107], v[100:103], v[36:39]
ds_read_b64_tr_b16 v[140:141], v23 offset:24576
v_mfma_f32_16x16x32_bf16 v[40:43], v[108:111], v[88:91], v[40:43]
ds_read_b64_tr_b16 v[142:143], v23 offset:25600
v_mfma_f32_16x16x32_bf16 v[44:47], v[108:111], v[92:95], v[44:47]
ds_read_b128 v[124:127], v19 offset:18432
v_mfma_f32_16x16x32_bf16 v[48:51], v[108:111], v[96:99], v[48:51]
ds_read_b64_tr_b16 v[144:145], v22 offset:24832
v_mfma_f32_16x16x32_bf16 v[52:55], v[108:111], v[100:103], v[52:55]
ds_read_b64_tr_b16 v[146:147], v22 offset:25856
v_mfma_f32_16x16x32_bf16 v[56:59], v[112:115], v[88:91], v[56:59]
ds_read_b128 v[128:131], v19 offset:20480
v_mfma_f32_16x16x32_bf16 v[60:63], v[112:115], v[92:95], v[60:63]
ds_read_b64_tr_b16 v[148:149], v23 offset:24832
v_mfma_f32_16x16x32_bf16 v[64:67], v[112:115], v[96:99], v[64:67]
ds_read_b64_tr_b16 v[150:151], v23 offset:25856
v_mfma_f32_16x16x32_bf16 v[68:71], v[112:115], v[100:103], v[68:71]
ds_read_b128 v[132:135], v19 offset:22528
v_mfma_f32_16x16x32_bf16 v[72:75], v[116:119], v[88:91], v[72:75]
v_mfma_f32_16x16x32_bf16 v[76:79], v[116:119], v[92:95], v[76:79]
v_mfma_f32_16x16x32_bf16 v[80:83], v[116:119], v[96:99], v[80:83]
v_mfma_f32_16x16x32_bf16 v[84:87], v[116:119], v[100:103], v[84:87]
s_waitcnt lgkmcnt(0)
s_barrier
v_mfma_f32_16x16x32_bf16 v[24:27], v[136:139], v[120:123], v[24:27]
ds_read_b64_tr_b16 v[104:105], v15 offset:0
v_mfma_f32_16x16x32_bf16 v[28:31], v[136:139], v[124:127], v[28:31]
ds_read_b64_tr_b16 v[106:107], v15 offset:1024
v_mfma_f32_16x16x32_bf16 v[32:35], v[136:139], v[128:131], v[32:35]
ds_read_b128 v[88:91], v14 offset:0
v_mfma_f32_16x16x32_bf16 v[36:39], v[136:139], v[132:135], v[36:39]
ds_read_b64_tr_b16 v[108:109], v16 offset:0
v_mfma_f32_16x16x32_bf16 v[40:43], v[140:143], v[120:123], v[40:43]
ds_read_b64_tr_b16 v[110:111], v16 offset:1024
v_mfma_f32_16x16x32_bf16 v[44:47], v[140:143], v[124:127], v[44:47]
ds_read_b128 v[92:95], v14 offset:2048
v_mfma_f32_16x16x32_bf16 v[48:51], v[140:143], v[128:131], v[48:51]
ds_read_b64_tr_b16 v[112:113], v15 offset:256
v_mfma_f32_16x16x32_bf16 v[52:55], v[140:143], v[132:135], v[52:55]
ds_read_b64_tr_b16 v[114:115], v15 offset:1280
v_mfma_f32_16x16x32_bf16 v[56:59], v[144:147], v[120:123], v[56:59]
ds_read_b128 v[96:99], v14 offset:4096
v_mfma_f32_16x16x32_bf16 v[60:63], v[144:147], v[124:127], v[60:63]
ds_read_b64_tr_b16 v[116:117], v16 offset:256
v_mfma_f32_16x16x32_bf16 v[64:67], v[144:147], v[128:131], v[64:67]
ds_read_b64_tr_b16 v[118:119], v16 offset:1280
v_mfma_f32_16x16x32_bf16 v[68:71], v[144:147], v[132:135], v[68:71]
ds_read_b128 v[100:103], v14 offset:6144
v_mfma_f32_16x16x32_bf16 v[72:75], v[148:151], v[120:123], v[72:75]
v_mfma_f32_16x16x32_bf16 v[76:79], v[148:151], v[124:127], v[76:79]
v_mfma_f32_16x16x32_bf16 v[80:83], v[148:151], v[128:131], v[80:83]
v_mfma_f32_16x16x32_bf16 v[84:87], v[148:151], v[132:135], v[84:87]
s_waitcnt lgkmcnt(0)
s_barrier
v_mfma_f32_16x16x32_bf16 v[24:27], v[104:107], v[88:91], v[24:27]
ds_read_b64_tr_b16 v[136:137], v15 offset:8192
v_mfma_f32_16x16x32_bf16 v[28:31], v[104:107], v[92:95], v[28:31]
ds_read_b64_tr_b16 v[138:139], v15 offset:9216
v_mfma_f32_16x16x32_bf16 v[32:35], v[104:107], v[96:99], v[32:35]
ds_read_b128 v[120:123], v17 offset:0
v_mfma_f32_16x16x32_bf16 v[36:39], v[104:107], v[100:103], v[36:39]
ds_read_b64_tr_b16 v[140:141], v16 offset:8192
v_mfma_f32_16x16x32_bf16 v[40:43], v[108:111], v[88:91], v[40:43]
ds_read_b64_tr_b16 v[142:143], v16 offset:9216
v_mfma_f32_16x16x32_bf16 v[44:47], v[108:111], v[92:95], v[44:47]
ds_read_b128 v[124:127], v17 offset:2048
v_mfma_f32_16x16x32_bf16 v[48:51], v[108:111], v[96:99], v[48:51]
ds_read_b64_tr_b16 v[144:145], v15 offset:8448
v_mfma_f32_16x16x32_bf16 v[52:55], v[108:111], v[100:103], v[52:55]
ds_read_b64_tr_b16 v[146:147], v15 offset:9472
v_mfma_f32_16x16x32_bf16 v[56:59], v[112:115], v[88:91], v[56:59]
ds_read_b128 v[128:131], v17 offset:4096
v_mfma_f32_16x16x32_bf16 v[60:63], v[112:115], v[92:95], v[60:63]
ds_read_b64_tr_b16 v[148:149], v16 offset:8448
v_mfma_f32_16x16x32_bf16 v[64:67], v[112:115], v[96:99], v[64:67]
ds_read_b64_tr_b16 v[150:151], v16 offset:9472
v_mfma_f32_16x16x32_bf16 v[68:71], v[112:115], v[100:103], v[68:71]
ds_read_b128 v[132:135], v17 offset:6144
v_mfma_f32_16x16x32_bf16 v[72:75], v[116:119], v[88:91], v[72:75]
v_mfma_f32_16x16x32_bf16 v[76:79], v[116:119], v[92:95], v[76:79]
v_mfma_f32_16x16x32_bf16 v[80:83], v[116:119], v[96:99], v[80:83]
v_mfma_f32_16x16x32_bf16 v[84:87], v[116:119], v[100:103], v[84:87]
s_waitcnt lgkmcnt(0)
s_barrier
v_mfma_f32_16x16x32_bf16 v[24:27], v[136:139], v[120:123], v[24:27]
ds_read_b64_tr_b16 v[104:105], v15 offset:16384
v_mfma_f32_16x16x32_bf16 v[28:31], v[136:139], v[124:127], v[28:31]
ds_read_b64_tr_b16 v[106:107], v15 offset:17408
v_mfma_f32_16x16x32_bf16 v[32:35], v[136:139], v[128:131], v[32:35]
ds_read_b128 v[88:91], v14 offset:16384
v_mfma_f32_16x16x32_bf16 v[36:39], v[136:139], v[132:135], v[36:39]
ds_read_b64_tr_b16 v[108:109], v16 offset:16384
v_mfma_f32_16x16x32_bf16 v[40:43], v[140:143], v[120:123], v[40:43]
ds_read_b64_tr_b16 v[110:111], v16 offset:17408
v_mfma_f32_16x16x32_bf16 v[44:47], v[140:143], v[124:127], v[44:47]
ds_read_b128 v[92:95], v14 offset:18432
v_mfma_f32_16x16x32_bf16 v[48:51], v[140:143], v[128:131], v[48:51]
ds_read_b64_tr_b16 v[112:113], v15 offset:16640
v_mfma_f32_16x16x32_bf16 v[52:55], v[140:143], v[132:135], v[52:55]
ds_read_b64_tr_b16 v[114:115], v15 offset:17664
v_mfma_f32_16x16x32_bf16 v[56:59], v[144:147], v[120:123], v[56:59]
ds_read_b128 v[96:99], v14 offset:20480
v_mfma_f32_16x16x32_bf16 v[60:63], v[144:147], v[124:127], v[60:63]
ds_read_b64_tr_b16 v[116:117], v16 offset:16640
v_mfma_f32_16x16x32_bf16 v[64:67], v[144:147], v[128:131], v[64:67]
ds_read_b64_tr_b16 v[118:119], v16 offset:17664
v_mfma_f32_16x16x32_bf16 v[68:71], v[144:147], v[132:135], v[68:71]
ds_read_b128 v[100:103], v14 offset:22528
v_mfma_f32_16x16x32_bf16 v[72:75], v[148:151], v[120:123], v[72:75]
v_mfma_f32_16x16x32_bf16 v[76:79], v[148:151], v[124:127], v[76:79]
v_mfma_f32_16x16x32_bf16 v[80:83], v[148:151], v[128:131], v[80:83]
v_mfma_f32_16x16x32_bf16 v[84:87], v[148:151], v[132:135], v[84:87]
s_waitcnt lgkmcnt(0)
s_barrier
v_mfma_f32_16x16x32_bf16 v[24:27], v[104:107], v[88:91], v[24:27]
ds_read_b64_tr_b16 v[136:137], v15 offset:24576
v_mfma_f32_16x16x32_bf16 v[28:31], v[104:107], v[92:95], v[28:31]
ds_read_b64_tr_b16 v[138:139], v15 offset:25600
v_mfma_f32_16x16x32_bf16 v[32:35], v[104:107], v[96:99], v[32:35]
ds_read_b128 v[120:123], v17 offset:16384
v_mfma_f32_16x16x32_bf16 v[36:39], v[104:107], v[100:103], v[36:39]
ds_read_b64_tr_b16 v[140:141], v16 offset:24576
v_mfma_f32_16x16x32_bf16 v[40:43], v[108:111], v[88:91], v[40:43]
ds_read_b64_tr_b16 v[142:143], v16 offset:25600
v_mfma_f32_16x16x32_bf16 v[44:47], v[108:111], v[92:95], v[44:47]
ds_read_b128 v[124:127], v17 offset:18432
v_mfma_f32_16x16x32_bf16 v[48:51], v[108:111], v[96:99], v[48:51]
ds_read_b64_tr_b16 v[144:145], v15 offset:24832
v_mfma_f32_16x16x32_bf16 v[52:55], v[108:111], v[100:103], v[52:55]
ds_read_b64_tr_b16 v[146:147], v15 offset:25856
v_mfma_f32_16x16x32_bf16 v[56:59], v[112:115], v[88:91], v[56:59]
ds_read_b128 v[128:131], v17 offset:20480
v_mfma_f32_16x16x32_bf16 v[60:63], v[112:115], v[92:95], v[60:63]
ds_read_b64_tr_b16 v[148:149], v16 offset:24832
v_mfma_f32_16x16x32_bf16 v[64:67], v[112:115], v[96:99], v[64:67]
ds_read_b64_tr_b16 v[150:151], v16 offset:25856
v_mfma_f32_16x16x32_bf16 v[68:71], v[112:115], v[100:103], v[68:71]
ds_read_b128 v[132:135], v17 offset:22528
v_mfma_f32_16x16x32_bf16 v[72:75], v[116:119], v[88:91], v[72:75]
v_mfma_f32_16x16x32_bf16 v[76:79], v[116:119], v[92:95], v[76:79]
v_mfma_f32_16x16x32_bf16 v[80:83], v[116:119], v[96:99], v[80:83]
v_mfma_f32_16x16x32_bf16 v[84:87], v[116:119], v[100:103], v[84:87]
s_waitcnt lgkmcnt(0)
s_barrier
v_mfma_f32_16x16x32_bf16 v[24:27], v[136:139], v[120:123], v[24:27]
ds_read_b64_tr_b16 v[104:105], v15 offset:32768
v_mfma_f32_16x16x32_bf16 v[28:31], v[136:139], v[124:127], v[28:31]
ds_read_b64_tr_b16 v[106:107], v15 offset:33792
v_mfma_f32_16x16x32_bf16 v[32:35], v[136:139], v[128:131], v[32:35]
ds_read_b128 v[88:91], v14 offset:32768
v_mfma_f32_16x16x32_bf16 v[36:39], v[136:139], v[132:135], v[36:39]
ds_read_b64_tr_b16 v[108:109], v16 offset:32768
v_mfma_f32_16x16x32_bf16 v[40:43], v[140:143], v[120:123], v[40:43]
ds_read_b64_tr_b16 v[110:111], v16 offset:33792
v_mfma_f32_16x16x32_bf16 v[44:47], v[140:143], v[124:127], v[44:47]
ds_read_b128 v[92:95], v14 offset:34816
v_mfma_f32_16x16x32_bf16 v[48:51], v[140:143], v[128:131], v[48:51]
ds_read_b64_tr_b16 v[112:113], v15 offset:33024
v_mfma_f32_16x16x32_bf16 v[52:55], v[140:143], v[132:135], v[52:55]
ds_read_b64_tr_b16 v[114:115], v15 offset:34048
v_mfma_f32_16x16x32_bf16 v[56:59], v[144:147], v[120:123], v[56:59]
ds_read_b128 v[96:99], v14 offset:36864
v_mfma_f32_16x16x32_bf16 v[60:63], v[144:147], v[124:127], v[60:63]
ds_read_b64_tr_b16 v[116:117], v16 offset:33024
v_mfma_f32_16x16x32_bf16 v[64:67], v[144:147], v[128:131], v[64:67]
ds_read_b64_tr_b16 v[118:119], v16 offset:34048
v_mfma_f32_16x16x32_bf16 v[68:71], v[144:147], v[132:135], v[68:71]
ds_read_b128 v[100:103], v14 offset:38912
v_mfma_f32_16x16x32_bf16 v[72:75], v[148:151], v[120:123], v[72:75]
v_mfma_f32_16x16x32_bf16 v[76:79], v[148:151], v[124:127], v[76:79]
v_mfma_f32_16x16x32_bf16 v[80:83], v[148:151], v[128:131], v[80:83]
v_mfma_f32_16x16x32_bf16 v[84:87], v[148:151], v[132:135], v[84:87]
s_waitcnt lgkmcnt(0)
s_barrier
v_mfma_f32_16x16x32_bf16 v[24:27], v[104:107], v[88:91], v[24:27]
ds_read_b64_tr_b16 v[136:137], v15 offset:40960
v_mfma_f32_16x16x32_bf16 v[28:31], v[104:107], v[92:95], v[28:31]
ds_read_b64_tr_b16 v[138:139], v15 offset:41984
v_mfma_f32_16x16x32_bf16 v[32:35], v[104:107], v[96:99], v[32:35]
ds_read_b128 v[120:123], v17 offset:32768
v_mfma_f32_16x16x32_bf16 v[36:39], v[104:107], v[100:103], v[36:39]
ds_read_b64_tr_b16 v[140:141], v16 offset:40960
v_mfma_f32_16x16x32_bf16 v[40:43], v[108:111], v[88:91], v[40:43]
ds_read_b64_tr_b16 v[142:143], v16 offset:41984
v_mfma_f32_16x16x32_bf16 v[44:47], v[108:111], v[92:95], v[44:47]
ds_read_b128 v[124:127], v17 offset:34816
v_mfma_f32_16x16x32_bf16 v[48:51], v[108:111], v[96:99], v[48:51]
ds_read_b64_tr_b16 v[144:145], v15 offset:41216
v_mfma_f32_16x16x32_bf16 v[52:55], v[108:111], v[100:103], v[52:55]
ds_read_b64_tr_b16 v[146:147], v15 offset:42240
v_mfma_f32_16x16x32_bf16 v[56:59], v[112:115], v[88:91], v[56:59]
ds_read_b128 v[128:131], v17 offset:36864
v_mfma_f32_16x16x32_bf16 v[60:63], v[112:115], v[92:95], v[60:63]
ds_read_b64_tr_b16 v[148:149], v16 offset:41216
v_mfma_f32_16x16x32_bf16 v[64:67], v[112:115], v[96:99], v[64:67]
ds_read_b64_tr_b16 v[150:151], v16 offset:42240
v_mfma_f32_16x16x32_bf16 v[68:71], v[112:115], v[100:103], v[68:71]
ds_read_b128 v[132:135], v17 offset:38912
v_mfma_f32_16x16x32_bf16 v[72:75], v[116:119], v[88:91], v[72:75]
v_mfma_f32_16x16x32_bf16 v[76:79], v[116:119], v[92:95], v[76:79]
v_mfma_f32_16x16x32_bf16 v[80:83], v[116:119], v[96:99], v[80:83]
v_mfma_f32_16x16x32_bf16 v[84:87], v[116:119], v[100:103], v[84:87]
s_waitcnt lgkmcnt(0)
s_barrier
v_mfma_f32_16x16x32_bf16 v[24:27], v[136:139], v[120:123], v[24:27]
ds_read_b64_tr_b16 v[104:105], v22 offset:0
v_mfma_f32_16x16x32_bf16 v[28:31], v[136:139], v[124:127], v[28:31]
ds_read_b64_tr_b16 v[106:107], v22 offset:1024
v_mfma_f32_16x16x32_bf16 v[32:35], v[136:139], v[128:131], v[32:35]
ds_read_b128 v[88:91], v18 offset:0
v_mfma_f32_16x16x32_bf16 v[36:39], v[136:139], v[132:135], v[36:39]
ds_read_b64_tr_b16 v[108:109], v23 offset:0
v_mfma_f32_16x16x32_bf16 v[40:43], v[140:143], v[120:123], v[40:43]
ds_read_b64_tr_b16 v[110:111], v23 offset:1024
v_mfma_f32_16x16x32_bf16 v[44:47], v[140:143], v[124:127], v[44:47]
ds_read_b128 v[92:95], v18 offset:2048
v_mfma_f32_16x16x32_bf16 v[48:51], v[140:143], v[128:131], v[48:51]
ds_read_b64_tr_b16 v[112:113], v22 offset:256
v_mfma_f32_16x16x32_bf16 v[52:55], v[140:143], v[132:135], v[52:55]
ds_read_b64_tr_b16 v[114:115], v22 offset:1280
v_mfma_f32_16x16x32_bf16 v[56:59], v[144:147], v[120:123], v[56:59]
ds_read_b128 v[96:99], v18 offset:4096
v_mfma_f32_16x16x32_bf16 v[60:63], v[144:147], v[124:127], v[60:63]
ds_read_b64_tr_b16 v[116:117], v23 offset:256
v_mfma_f32_16x16x32_bf16 v[64:67], v[144:147], v[128:131], v[64:67]
ds_read_b64_tr_b16 v[118:119], v23 offset:1280
v_mfma_f32_16x16x32_bf16 v[68:71], v[144:147], v[132:135], v[68:71]
ds_read_b128 v[100:103], v18 offset:6144
v_mfma_f32_16x16x32_bf16 v[72:75], v[148:151], v[120:123], v[72:75]
v_mfma_f32_16x16x32_bf16 v[76:79], v[148:151], v[124:127], v[76:79]
v_mfma_f32_16x16x32_bf16 v[80:83], v[148:151], v[128:131], v[80:83]
v_mfma_f32_16x16x32_bf16 v[84:87], v[148:151], v[132:135], v[84:87]
s_waitcnt lgkmcnt(0)
s_barrier
v_mfma_f32_16x16x32_bf16 v[24:27], v[104:107], v[88:91], v[24:27]
ds_read_b64_tr_b16 v[136:137], v22 offset:8192
v_mfma_f32_16x16x32_bf16 v[28:31], v[104:107], v[92:95], v[28:31]
ds_read_b64_tr_b16 v[138:139], v22 offset:9216
v_mfma_f32_16x16x32_bf16 v[32:35], v[104:107], v[96:99], v[32:35]
ds_read_b128 v[120:123], v19 offset:0
v_mfma_f32_16x16x32_bf16 v[36:39], v[104:107], v[100:103], v[36:39]
ds_read_b64_tr_b16 v[140:141], v23 offset:8192
v_mfma_f32_16x16x32_bf16 v[40:43], v[108:111], v[88:91], v[40:43]
ds_read_b64_tr_b16 v[142:143], v23 offset:9216
v_mfma_f32_16x16x32_bf16 v[44:47], v[108:111], v[92:95], v[44:47]
ds_read_b128 v[124:127], v19 offset:2048
v_mfma_f32_16x16x32_bf16 v[48:51], v[108:111], v[96:99], v[48:51]
ds_read_b64_tr_b16 v[144:145], v22 offset:8448
v_mfma_f32_16x16x32_bf16 v[52:55], v[108:111], v[100:103], v[52:55]
ds_read_b64_tr_b16 v[146:147], v22 offset:9472
v_mfma_f32_16x16x32_bf16 v[56:59], v[112:115], v[88:91], v[56:59]
ds_read_b128 v[128:131], v19 offset:4096
v_mfma_f32_16x16x32_bf16 v[60:63], v[112:115], v[92:95], v[60:63]
ds_read_b64_tr_b16 v[148:149], v23 offset:8448
v_mfma_f32_16x16x32_bf16 v[64:67], v[112:115], v[96:99], v[64:67]
ds_read_b64_tr_b16 v[150:151], v23 offset:9472
v_mfma_f32_16x16x32_bf16 v[68:71], v[112:115], v[100:103], v[68:71]
ds_read_b128 v[132:135], v19 offset:6144
v_mfma_f32_16x16x32_bf16 v[72:75], v[116:119], v[88:91], v[72:75]
v_mfma_f32_16x16x32_bf16 v[76:79], v[116:119], v[92:95], v[76:79]
v_mfma_f32_16x16x32_bf16 v[80:83], v[116:119], v[96:99], v[80:83]
v_mfma_f32_16x16x32_bf16 v[84:87], v[116:119], v[100:103], v[84:87]
s_waitcnt lgkmcnt(0)
s_barrier
v_mfma_f32_16x16x32_bf16 v[24:27], v[136:139], v[120:123], v[24:27]
ds_read_b64_tr_b16 v[104:105], v22 offset:16384
v_mfma_f32_16x16x32_bf16 v[28:31], v[136:139], v[124:127], v[28:31]
ds_read_b64_tr_b16 v[106:107], v22 offset:17408
v_mfma_f32_16x16x32_bf16 v[32:35], v[136:139], v[128:131], v[32:35]
ds_read_b128 v[88:91], v18 offset:16384
v_mfma_f32_16x16x32_bf16 v[36:39], v[136:139], v[132:135], v[36:39]
ds_read_b64_tr_b16 v[108:109], v23 offset:16384
v_mfma_f32_16x16x32_bf16 v[40:43], v[140:143], v[120:123], v[40:43]
ds_read_b64_tr_b16 v[110:111], v23 offset:17408
v_mfma_f32_16x16x32_bf16 v[44:47], v[140:143], v[124:127], v[44:47]
ds_read_b128 v[92:95], v18 offset:18432
v_mfma_f32_16x16x32_bf16 v[48:51], v[140:143], v[128:131], v[48:51]
ds_read_b64_tr_b16 v[112:113], v22 offset:16640
v_mfma_f32_16x16x32_bf16 v[52:55], v[140:143], v[132:135], v[52:55]
ds_read_b64_tr_b16 v[114:115], v22 offset:17664
v_mfma_f32_16x16x32_bf16 v[56:59], v[144:147], v[120:123], v[56:59]
ds_read_b128 v[96:99], v18 offset:20480
v_mfma_f32_16x16x32_bf16 v[60:63], v[144:147], v[124:127], v[60:63]
ds_read_b64_tr_b16 v[116:117], v23 offset:16640
v_mfma_f32_16x16x32_bf16 v[64:67], v[144:147], v[128:131], v[64:67]
ds_read_b64_tr_b16 v[118:119], v23 offset:17664
v_mfma_f32_16x16x32_bf16 v[68:71], v[144:147], v[132:135], v[68:71]
ds_read_b128 v[100:103], v18 offset:22528
v_mfma_f32_16x16x32_bf16 v[72:75], v[148:151], v[120:123], v[72:75]
v_mfma_f32_16x16x32_bf16 v[76:79], v[148:151], v[124:127], v[76:79]
v_mfma_f32_16x16x32_bf16 v[80:83], v[148:151], v[128:131], v[80:83]
v_mfma_f32_16x16x32_bf16 v[84:87], v[148:151], v[132:135], v[84:87]
s_waitcnt lgkmcnt(0)
s_barrier
v_mfma_f32_16x16x32_bf16 v[24:27], v[104:107], v[88:91], v[24:27]
ds_read_b64_tr_b16 v[136:137], v22 offset:24576
v_mfma_f32_16x16x32_bf16 v[28:31], v[104:107], v[92:95], v[28:31]
ds_read_b64_tr_b16 v[138:139], v22 offset:25600
v_mfma_f32_16x16x32_bf16 v[32:35], v[104:107], v[96:99], v[32:35]
ds_read_b128 v[120:123], v19 offset:16384
v_mfma_f32_16x16x32_bf16 v[36:39], v[104:107], v[100:103], v[36:39]
ds_read_b64_tr_b16 v[140:141], v23 offset:24576
v_mfma_f32_16x16x32_bf16 v[40:43], v[108:111], v[88:91], v[40:43]
ds_read_b64_tr_b16 v[142:143], v23 offset:25600
v_mfma_f32_16x16x32_bf16 v[44:47], v[108:111], v[92:95], v[44:47]
ds_read_b128 v[124:127], v19 offset:18432
v_mfma_f32_16x16x32_bf16 v[48:51], v[108:111], v[96:99], v[48:51]
ds_read_b64_tr_b16 v[144:145], v22 offset:24832
v_mfma_f32_16x16x32_bf16 v[52:55], v[108:111], v[100:103], v[52:55]
ds_read_b64_tr_b16 v[146:147], v22 offset:25856
v_mfma_f32_16x16x32_bf16 v[56:59], v[112:115], v[88:91], v[56:59]
ds_read_b128 v[128:131], v19 offset:20480
v_mfma_f32_16x16x32_bf16 v[60:63], v[112:115], v[92:95], v[60:63]
ds_read_b64_tr_b16 v[148:149], v23 offset:24832
v_mfma_f32_16x16x32_bf16 v[64:67], v[112:115], v[96:99], v[64:67]
ds_read_b64_tr_b16 v[150:151], v23 offset:25856
v_mfma_f32_16x16x32_bf16 v[68:71], v[112:115], v[100:103], v[68:71]
ds_read_b128 v[132:135], v19 offset:22528
v_mfma_f32_16x16x32_bf16 v[72:75], v[116:119], v[88:91], v[72:75]
v_mfma_f32_16x16x32_bf16 v[76:79], v[116:119], v[92:95], v[76:79]
v_mfma_f32_16x16x32_bf16 v[80:83], v[116:119], v[96:99], v[80:83]
v_mfma_f32_16x16x32_bf16 v[84:87], v[116:119], v[100:103], v[84:87]
s_waitcnt lgkmcnt(0)
v_mfma_f32_16x16x32_bf16 v[24:27], v[136:139], v[120:123], v[24:27]
v_mfma_f32_16x16x32_bf16 v[28:31], v[136:139], v[124:127], v[28:31]
v_mfma_f32_16x16x32_bf16 v[32:35], v[136:139], v[128:131], v[32:35]
v_mfma_f32_16x16x32_bf16 v[36:39], v[136:139], v[132:135], v[36:39]
v_mfma_f32_16x16x32_bf16 v[40:43], v[140:143], v[120:123], v[40:43]
v_mfma_f32_16x16x32_bf16 v[44:47], v[140:143], v[124:127], v[44:47]
v_mfma_f32_16x16x32_bf16 v[48:51], v[140:143], v[128:131], v[48:51]
v_mfma_f32_16x16x32_bf16 v[52:55], v[140:143], v[132:135], v[52:55]
v_mfma_f32_16x16x32_bf16 v[56:59], v[144:147], v[120:123], v[56:59]
v_mfma_f32_16x16x32_bf16 v[60:63], v[144:147], v[124:127], v[60:63]
v_mfma_f32_16x16x32_bf16 v[64:67], v[144:147], v[128:131], v[64:67]
v_mfma_f32_16x16x32_bf16 v[68:71], v[144:147], v[132:135], v[68:71]
v_mfma_f32_16x16x32_bf16 v[72:75], v[148:151], v[120:123], v[72:75]
v_mfma_f32_16x16x32_bf16 v[76:79], v[148:151], v[124:127], v[76:79]
v_mfma_f32_16x16x32_bf16 v[80:83], v[148:151], v[128:131], v[80:83]
v_mfma_f32_16x16x32_bf16 v[84:87], v[148:151], v[132:135], v[84:87]
s_lshl_b32 s14, s4, 1
s_add_u32 s14, s14, s16
s_mul_i32 s14, s14, 54
s_lshl_b32 s10, s5, 2
s_add_u32 s14, s14, s10
s_lshl_b32 s10, s15, 1
s_add_u32 s14, s14, s10
s_lshl_b32 s14, s14, 12
v_max_f32 v24, 0, v24
v_max_f32 v25, 0, v25
v_max_f32 v26, 0, v26
v_max_f32 v27, 0, v27
v_pk_mul_f32 v[24:25], v[24:25], v[24:25]
v_pk_mul_f32 v[26:27], v[26:27], v[26:27]
v_cvt_pk_bf16_f32 v88, v24, v25
v_cvt_pk_bf16_f32 v89, v26, v27
v_max_f32 v40, 0, v40
v_max_f32 v41, 0, v41
v_max_f32 v42, 0, v42
v_max_f32 v43, 0, v43
v_pk_mul_f32 v[40:41], v[40:41], v[40:41]
v_pk_mul_f32 v[42:43], v[42:43], v[42:43]
v_cvt_pk_bf16_f32 v90, v40, v41
v_cvt_pk_bf16_f32 v91, v42, v43
buffer_store_dwordx4 v[88:91], v13, s[60:63], s14 offen offset:0 sc1
v_max_f32 v28, 0, v28
v_max_f32 v29, 0, v29
v_max_f32 v30, 0, v30
v_max_f32 v31, 0, v31
v_pk_mul_f32 v[28:29], v[28:29], v[28:29]
v_pk_mul_f32 v[30:31], v[30:31], v[30:31]
v_cvt_pk_bf16_f32 v92, v28, v29
v_cvt_pk_bf16_f32 v93, v30, v31
v_max_f32 v44, 0, v44
v_max_f32 v45, 0, v45
v_max_f32 v46, 0, v46
v_max_f32 v47, 0, v47
v_pk_mul_f32 v[44:45], v[44:45], v[44:45]
v_pk_mul_f32 v[46:47], v[46:47], v[46:47]
v_cvt_pk_bf16_f32 v94, v44, v45
v_cvt_pk_bf16_f32 v95, v46, v47
buffer_store_dwordx4 v[92:95], v13, s[60:63], s14 offen offset:1024 sc1
v_max_f32 v32, 0, v32
v_max_f32 v33, 0, v33
v_max_f32 v34, 0, v34
v_max_f32 v35, 0, v35
v_pk_mul_f32 v[32:33], v[32:33], v[32:33]
v_pk_mul_f32 v[34:35], v[34:35], v[34:35]
v_cvt_pk_bf16_f32 v96, v32, v33
v_cvt_pk_bf16_f32 v97, v34, v35
v_max_f32 v48, 0, v48
v_max_f32 v49, 0, v49
v_max_f32 v50, 0, v50
v_max_f32 v51, 0, v51
v_pk_mul_f32 v[48:49], v[48:49], v[48:49]
v_pk_mul_f32 v[50:51], v[50:51], v[50:51]
v_cvt_pk_bf16_f32 v98, v48, v49
v_cvt_pk_bf16_f32 v99, v50, v51
buffer_store_dwordx4 v[96:99], v13, s[60:63], s14 offen offset:2048 sc1
v_max_f32 v36, 0, v36
v_max_f32 v37, 0, v37
v_max_f32 v38, 0, v38
v_max_f32 v39, 0, v39
v_pk_mul_f32 v[36:37], v[36:37], v[36:37]
v_pk_mul_f32 v[38:39], v[38:39], v[38:39]
v_cvt_pk_bf16_f32 v100, v36, v37
v_cvt_pk_bf16_f32 v101, v38, v39
v_max_f32 v52, 0, v52
v_max_f32 v53, 0, v53
v_max_f32 v54, 0, v54
v_max_f32 v55, 0, v55
v_pk_mul_f32 v[52:53], v[52:53], v[52:53]
v_pk_mul_f32 v[54:55], v[54:55], v[54:55]
v_cvt_pk_bf16_f32 v102, v52, v53
v_cvt_pk_bf16_f32 v103, v54, v55
buffer_store_dwordx4 v[100:103], v13, s[60:63], s14 offen offset:3072 sc1
s_add_u32 s14, s14, 4096
v_max_f32 v56, 0, v56
v_max_f32 v57, 0, v57
v_max_f32 v58, 0, v58
v_max_f32 v59, 0, v59
v_pk_mul_f32 v[56:57], v[56:57], v[56:57]
v_pk_mul_f32 v[58:59], v[58:59], v[58:59]
v_cvt_pk_bf16_f32 v104, v56, v57
v_cvt_pk_bf16_f32 v105, v58, v59
v_max_f32 v72, 0, v72
v_max_f32 v73, 0, v73
v_max_f32 v74, 0, v74
v_max_f32 v75, 0, v75
v_pk_mul_f32 v[72:73], v[72:73], v[72:73]
v_pk_mul_f32 v[74:75], v[74:75], v[74:75]
v_cvt_pk_bf16_f32 v106, v72, v73
v_cvt_pk_bf16_f32 v107, v74, v75
buffer_store_dwordx4 v[104:107], v13, s[60:63], s14 offen offset:0 sc1
v_max_f32 v60, 0, v60
v_max_f32 v61, 0, v61
v_max_f32 v62, 0, v62
v_max_f32 v63, 0, v63
v_pk_mul_f32 v[60:61], v[60:61], v[60:61]
v_pk_mul_f32 v[62:63], v[62:63], v[62:63]
v_cvt_pk_bf16_f32 v108, v60, v61
v_cvt_pk_bf16_f32 v109, v62, v63
v_max_f32 v76, 0, v76
v_max_f32 v77, 0, v77
v_max_f32 v78, 0, v78
v_max_f32 v79, 0, v79
v_pk_mul_f32 v[76:77], v[76:77], v[76:77]
v_pk_mul_f32 v[78:79], v[78:79], v[78:79]
v_cvt_pk_bf16_f32 v110, v76, v77
v_cvt_pk_bf16_f32 v111, v78, v79
buffer_store_dwordx4 v[108:111], v13, s[60:63], s14 offen offset:1024 sc1
v_max_f32 v64, 0, v64
v_max_f32 v65, 0, v65
v_max_f32 v66, 0, v66
v_max_f32 v67, 0, v67
v_pk_mul_f32 v[64:65], v[64:65], v[64:65]
v_pk_mul_f32 v[66:67], v[66:67], v[66:67]
v_cvt_pk_bf16_f32 v112, v64, v65
v_cvt_pk_bf16_f32 v113, v66, v67
v_max_f32 v80, 0, v80
v_max_f32 v81, 0, v81
v_max_f32 v82, 0, v82
v_max_f32 v83, 0, v83
v_pk_mul_f32 v[80:81], v[80:81], v[80:81]
v_pk_mul_f32 v[82:83], v[82:83], v[82:83]
v_cvt_pk_bf16_f32 v114, v80, v81
v_cvt_pk_bf16_f32 v115, v82, v83
buffer_store_dwordx4 v[112:115], v13, s[60:63], s14 offen offset:2048 sc1
v_max_f32 v68, 0, v68
v_max_f32 v69, 0, v69
v_max_f32 v70, 0, v70
v_max_f32 v71, 0, v71
v_pk_mul_f32 v[68:69], v[68:69], v[68:69]
v_pk_mul_f32 v[70:71], v[70:71], v[70:71]
v_cvt_pk_bf16_f32 v116, v68, v69
v_cvt_pk_bf16_f32 v117, v70, v71
v_max_f32 v84, 0, v84
v_max_f32 v85, 0, v85
v_max_f32 v86, 0, v86
v_max_f32 v87, 0, v87
v_pk_mul_f32 v[84:85], v[84:85], v[84:85]
v_pk_mul_f32 v[86:87], v[86:87], v[86:87]
v_cvt_pk_bf16_f32 v118, v84, v85
v_cvt_pk_bf16_f32 v119, v86, v87
buffer_store_dwordx4 v[116:119], v13, s[60:63], s14 offen offset:3072 sc1
s_add_u32 s14, s14, 4096
s_endpgm
G1G_4:
s_mov_b32 s64, s40
s_mov_b32 s65, s41
s_mov_b32 s66, 0x500
s_mov_b32 s67, 0x20000
s_add_u32 s68, s46, 0xf10000
s_addc_u32 s69, s47, 0
s_mov_b32 s70, 0x2000
s_mov_b32 s71, 0x20000
v_lshlrev_b32 v5, 4, v4
s_mul_i32 s18, s3, 3
s_mul_i32 s19, s18, 26
s_lshr_b32 s19, s19, 8
s_mul_i32 s19, s19, 10
s_sub_u32 s18, s18, s19
s_lshl_b32 s19, s18, 7
buffer_load_dwordx4 v[24:27], v5, s[64:67], s19 offen offset:0
buffer_load_dwordx4 v[28:31], v5, s[64:67], s19 offen offset:64
s_add_u32 s18, s18, 1
s_cmp_eq_u32 s18, 10
s_cselect_b32 s18, 0, s18
s_lshl_b32 s19, s18, 7
buffer_load_dwordx4 v[32:35], v5, s[64:67], s19 offen offset:0
buffer_load_dwordx4 v[36:39], v5, s[64:67], s19 offen offset:64
s_add_u32 s18, s18, 1
s_cmp_eq_u32 s18, 10
s_cselect_b32 s18, 0, s18
s_lshl_b32 s19, s18, 7
buffer_load_dwordx4 v[40:43], v5, s[64:67], s19 offen offset:0
buffer_load_dwordx4 v[44:47], v5, s[64:67], s19 offen offset:64
s_add_u32 s18, s18, 1
s_cmp_eq_u32 s18, 10
s_cselect_b32 s18, 0, s18
s_lshl_b32 s19, s18, 7
buffer_load_dwordx4 v[48:51], v5, s[64:67], s19 offen offset:0
buffer_load_dwordx4 v[52:55], v5, s[64:67], s19 offen offset:64
s_add_u32 s18, s18, 1
s_cmp_eq_u32 s18, 10
s_cselect_b32 s18, 0, s18
s_lshl_b32 s19, s18, 7
buffer_load_dwordx4 v[56:59], v5, s[64:67], s19 offen offset:0
buffer_load_dwordx4 v[60:63], v5, s[64:67], s19 offen offset:64
s_add_u32 s18, s18, 1
s_cmp_eq_u32 s18, 10
s_cselect_b32 s18, 0, s18
s_lshl_b32 s19, s18, 7
buffer_load_dwordx4 v[64:67], v5, s[64:67], s19 offen offset:0
buffer_load_dwordx4 v[68:71], v5, s[64:67], s19 offen offset:64
s_add_u32 s18, s18, 1
s_cmp_eq_u32 s18, 10
s_cselect_b32 s18, 0, s18
s_lshl_b32 s19, s18, 7
buffer_load_dwordx4 v[72:75], v5, s[64:67], s19 offen offset:0
buffer_load_dwordx4 v[76:79], v5, s[64:67], s19 offen offset:64
s_add_u32 s18, s18, 1
s_cmp_eq_u32 s18, 10
s_cselect_b32 s18, 0, s18
s_lshl_b32 s19, s18, 7
buffer_load_dwordx4 v[80:83], v5, s[64:67], s19 offen offset:0
buffer_load_dwordx4 v[84:87], v5, s[64:67], s19 offen offset:64
s_add_u32 s18, s18, 1
s_cmp_eq_u32 s18, 10
s_cselect_b32 s18, 0, s18
s_lshl_b32 s19, s18, 7
buffer_load_dwordx4 v[88:91], v5, s[64:67], s19 offen offset:0
buffer_load_dwordx4 v[92:95], v5, s[64:67], s19 offen offset:64
s_add_u32 s18, s18, 1
s_cmp_eq_u32 s18, 10
s_cselect_b32 s18, 0, s18
s_lshl_b32 s19, s18, 7
buffer_load_dwordx4 v[96:99], v5, s[64:67], s19 offen offset:0
buffer_load_dwordx4 v[100:103], v5, s[64:67], s19 offen offset:64
s_add_u32 s18, s18, 1
s_cmp_eq_u32 s18, 10
s_cselect_b32 s18, 0, s18
s_waitcnt vmcnt(0)
s_barrier
ds_read_b128 v[104:107], v14 offset:0
ds_read_b128 v[108:111], v14 offset:2048
ds_read_b128 v[112:115], v14 offset:4096
ds_read_b128 v[116:119], v14 offset:6144
s_waitcnt lgkmcnt(0)
s_barrier
ds_read_b128 v[120:123], v17 offset:0
ds_read_b128 v[124:127], v17 offset:2048
ds_read_b128 v[128:131], v17 offset:4096
ds_read_b128 v[132:135], v17 offset:6144
v_mfma_f32_16x16x32_bf16 v[136:139], v[24:27], v[104:107], 0
v_mfma_f32_16x16x32_bf16 v[140:143], v[24:27], v[108:111], 0
v_mfma_f32_16x16x32_bf16 v[144:147], v[24:27], v[112:115], 0
v_mfma_f32_16x16x32_bf16 v[148:151], v[24:27], v[116:119], 0
s_waitcnt lgkmcnt(0)
s_barrier
ds_read_b128 v[104:107], v14 offset:16384
ds_read_b128 v[108:111], v14 offset:18432
ds_read_b128 v[112:115], v14 offset:20480
ds_read_b128 v[116:119], v14 offset:22528
v_mfma_f32_16x16x32_bf16 v[136:139], v[28:31], v[120:123], v[136:139]
v_mfma_f32_16x16x32_bf16 v[140:143], v[28:31], v[124:127], v[140:143]
v_mfma_f32_16x16x32_bf16 v[144:147], v[28:31], v[128:131], v[144:147]
v_mfma_f32_16x16x32_bf16 v[148:151], v[28:31], v[132:135], v[148:151]
s_waitcnt lgkmcnt(0)
s_barrier
ds_read_b128 v[120:123], v17 offset:16384
ds_read_b128 v[124:127], v17 offset:18432
ds_read_b128 v[128:131], v17 offset:20480
ds_read_b128 v[132:135], v17 offset:22528
v_mfma_f32_16x16x32_bf16 v[136:139], v[32:35], v[104:107], v[136:139]
v_mfma_f32_16x16x32_bf16 v[140:143], v[32:35], v[108:111], v[140:143]
v_mfma_f32_16x16x32_bf16 v[144:147], v[32:35], v[112:115], v[144:147]
v_mfma_f32_16x16x32_bf16 v[148:151], v[32:35], v[116:119], v[148:151]
s_waitcnt lgkmcnt(0)
s_barrier
ds_read_b128 v[104:107], v14 offset:32768
ds_read_b128 v[108:111], v14 offset:34816
ds_read_b128 v[112:115], v14 offset:36864
ds_read_b128 v[116:119], v14 offset:38912
v_mfma_f32_16x16x32_bf16 v[136:139], v[36:39], v[120:123], v[136:139]
v_mfma_f32_16x16x32_bf16 v[140:143], v[36:39], v[124:127], v[140:143]
v_mfma_f32_16x16x32_bf16 v[144:147], v[36:39], v[128:131], v[144:147]
v_mfma_f32_16x16x32_bf16 v[148:151], v[36:39], v[132:135], v[148:151]
s_waitcnt lgkmcnt(0)
s_barrier
ds_read_b128 v[120:123], v17 offset:32768
ds_read_b128 v[124:127], v17 offset:34816
ds_read_b128 v[128:131], v17 offset:36864
ds_read_b128 v[132:135], v17 offset:38912
v_mfma_f32_16x16x32_bf16 v[136:139], v[40:43], v[104:107], v[136:139]
v_mfma_f32_16x16x32_bf16 v[140:143], v[40:43], v[108:111], v[140:143]
v_mfma_f32_16x16x32_bf16 v[144:147], v[40:43], v[112:115], v[144:147]
v_mfma_f32_16x16x32_bf16 v[148:151], v[40:43], v[116:119], v[148:151]
s_waitcnt lgkmcnt(0)
s_barrier
ds_read_b128 v[104:107], v18 offset:0
ds_read_b128 v[108:111], v18 offset:2048
ds_read_b128 v[112:115], v18 offset:4096
ds_read_b128 v[116:119], v18 offset:6144
v_mfma_f32_16x16x32_bf16 v[136:139], v[44:47], v[120:123], v[136:139]
v_mfma_f32_16x16x32_bf16 v[140:143], v[44:47], v[124:127], v[140:143]
v_mfma_f32_16x16x32_bf16 v[144:147], v[44:47], v[128:131], v[144:147]
v_mfma_f32_16x16x32_bf16 v[148:151], v[44:47], v[132:135], v[148:151]
s_waitcnt lgkmcnt(0)
s_barrier
ds_read_b128 v[120:123], v19 offset:0
ds_read_b128 v[124:127], v19 offset:2048
ds_read_b128 v[128:131], v19 offset:4096
ds_read_b128 v[132:135], v19 offset:6144
v_mfma_f32_16x16x32_bf16 v[136:139], v[48:51], v[104:107], v[136:139]
v_mfma_f32_16x16x32_bf16 v[140:143], v[48:51], v[108:111], v[140:143]
v_mfma_f32_16x16x32_bf16 v[144:147], v[48:51], v[112:115], v[144:147]
v_mfma_f32_16x16x32_bf16 v[148:151], v[48:51], v[116:119], v[148:151]
s_waitcnt lgkmcnt(0)
s_barrier
ds_read_b128 v[104:107], v18 offset:16384
ds_read_b128 v[108:111], v18 offset:18432
ds_read_b128 v[112:115], v18 offset:20480
ds_read_b128 v[116:119], v18 offset:22528
v_mfma_f32_16x16x32_bf16 v[136:139], v[52:55], v[120:123], v[136:139]
v_mfma_f32_16x16x32_bf16 v[140:143], v[52:55], v[124:127], v[140:143]
v_mfma_f32_16x16x32_bf16 v[144:147], v[52:55], v[128:131], v[144:147]
v_mfma_f32_16x16x32_bf16 v[148:151], v[52:55], v[132:135], v[148:151]
s_waitcnt lgkmcnt(0)
s_barrier
ds_read_b128 v[120:123], v19 offset:16384
ds_read_b128 v[124:127], v19 offset:18432
ds_read_b128 v[128:131], v19 offset:20480
ds_read_b128 v[132:135], v19 offset:22528
v_mfma_f32_16x16x32_bf16 v[136:139], v[56:59], v[104:107], v[136:139]
v_mfma_f32_16x16x32_bf16 v[140:143], v[56:59], v[108:111], v[140:143]
v_mfma_f32_16x16x32_bf16 v[144:147], v[56:59], v[112:115], v[144:147]
v_mfma_f32_16x16x32_bf16 v[148:151], v[56:59], v[116:119], v[148:151]
s_waitcnt lgkmcnt(0)
s_barrier
ds_read_b128 v[104:107], v14 offset:0
ds_read_b128 v[108:111], v14 offset:2048
ds_read_b128 v[112:115], v14 offset:4096
ds_read_b128 v[116:119], v14 offset:6144
v_mfma_f32_16x16x32_bf16 v[136:139], v[60:63], v[120:123], v[136:139]
v_mfma_f32_16x16x32_bf16 v[140:143], v[60:63], v[124:127], v[140:143]
v_mfma_f32_16x16x32_bf16 v[144:147], v[60:63], v[128:131], v[144:147]
v_mfma_f32_16x16x32_bf16 v[148:151], v[60:63], v[132:135], v[148:151]
s_waitcnt lgkmcnt(0)
s_barrier
ds_read_b128 v[120:123], v17 offset:0
ds_read_b128 v[124:127], v17 offset:2048
ds_read_b128 v[128:131], v17 offset:4096
ds_read_b128 v[132:135], v17 offset:6144
v_mfma_f32_16x16x32_bf16 v[136:139], v[64:67], v[104:107], v[136:139]
v_mfma_f32_16x16x32_bf16 v[140:143], v[64:67], v[108:111], v[140:143]
v_mfma_f32_16x16x32_bf16 v[144:147], v[64:67], v[112:115], v[144:147]
v_mfma_f32_16x16x32_bf16 v[148:151], v[64:67], v[116:119], v[148:151]
s_waitcnt lgkmcnt(0)
s_barrier
ds_read_b128 v[104:107], v14 offset:16384
ds_read_b128 v[108:111], v14 offset:18432
ds_read_b128 v[112:115], v14 offset:20480
ds_read_b128 v[116:119], v14 offset:22528
v_mfma_f32_16x16x32_bf16 v[136:139], v[68:71], v[120:123], v[136:139]
v_mfma_f32_16x16x32_bf16 v[140:143], v[68:71], v[124:127], v[140:143]
v_mfma_f32_16x16x32_bf16 v[144:147], v[68:71], v[128:131], v[144:147]
v_mfma_f32_16x16x32_bf16 v[148:151], v[68:71], v[132:135], v[148:151]
s_waitcnt lgkmcnt(0)
s_barrier
ds_read_b128 v[120:123], v17 offset:16384
ds_read_b128 v[124:127], v17 offset:18432
ds_read_b128 v[128:131], v17 offset:20480
ds_read_b128 v[132:135], v17 offset:22528
v_mfma_f32_16x16x32_bf16 v[136:139], v[72:75], v[104:107], v[136:139]
v_mfma_f32_16x16x32_bf16 v[140:143], v[72:75], v[108:111], v[140:143]
v_mfma_f32_16x16x32_bf16 v[144:147], v[72:75], v[112:115], v[144:147]
v_mfma_f32_16x16x32_bf16 v[148:151], v[72:75], v[116:119], v[148:151]
s_waitcnt lgkmcnt(0)
s_barrier
ds_read_b128 v[104:107], v14 offset:32768
ds_read_b128 v[108:111], v14 offset:34816
ds_read_b128 v[112:115], v14 offset:36864
ds_read_b128 v[116:119], v14 offset:38912
v_mfma_f32_16x16x32_bf16 v[136:139], v[76:79], v[120:123], v[136:139]
v_mfma_f32_16x16x32_bf16 v[140:143], v[76:79], v[124:127], v[140:143]
v_mfma_f32_16x16x32_bf16 v[144:147], v[76:79], v[128:131], v[144:147]
v_mfma_f32_16x16x32_bf16 v[148:151], v[76:79], v[132:135], v[148:151]
s_waitcnt lgkmcnt(0)
s_barrier
ds_read_b128 v[120:123], v17 offset:32768
ds_read_b128 v[124:127], v17 offset:34816
ds_read_b128 v[128:131], v17 offset:36864
ds_read_b128 v[132:135], v17 offset:38912
v_mfma_f32_16x16x32_bf16 v[136:139], v[80:83], v[104:107], v[136:139]
v_mfma_f32_16x16x32_bf16 v[140:143], v[80:83], v[108:111], v[140:143]
v_mfma_f32_16x16x32_bf16 v[144:147], v[80:83], v[112:115], v[144:147]
v_mfma_f32_16x16x32_bf16 v[148:151], v[80:83], v[116:119], v[148:151]
s_waitcnt lgkmcnt(0)
s_barrier
ds_read_b128 v[104:107], v18 offset:0
ds_read_b128 v[108:111], v18 offset:2048
ds_read_b128 v[112:115], v18 offset:4096
ds_read_b128 v[116:119], v18 offset:6144
v_mfma_f32_16x16x32_bf16 v[136:139], v[84:87], v[120:123], v[136:139]
v_mfma_f32_16x16x32_bf16 v[140:143], v[84:87], v[124:127], v[140:143]
v_mfma_f32_16x16x32_bf16 v[144:147], v[84:87], v[128:131], v[144:147]
v_mfma_f32_16x16x32_bf16 v[148:151], v[84:87], v[132:135], v[148:151]
s_waitcnt lgkmcnt(0)
s_barrier
ds_read_b128 v[120:123], v19 offset:0
ds_read_b128 v[124:127], v19 offset:2048
ds_read_b128 v[128:131], v19 offset:4096
ds_read_b128 v[132:135], v19 offset:6144
v_mfma_f32_16x16x32_bf16 v[136:139], v[88:91], v[104:107], v[136:139]
v_mfma_f32_16x16x32_bf16 v[140:143], v[88:91], v[108:111], v[140:143]
v_mfma_f32_16x16x32_bf16 v[144:147], v[88:91], v[112:115], v[144:147]
v_mfma_f32_16x16x32_bf16 v[148:151], v[88:91], v[116:119], v[148:151]
s_waitcnt lgkmcnt(0)
s_barrier
ds_read_b128 v[104:107], v18 offset:16384
ds_read_b128 v[108:111], v18 offset:18432
ds_read_b128 v[112:115], v18 offset:20480
ds_read_b128 v[116:119], v18 offset:22528
v_mfma_f32_16x16x32_bf16 v[136:139], v[92:95], v[120:123], v[136:139]
v_mfma_f32_16x16x32_bf16 v[140:143], v[92:95], v[124:127], v[140:143]
v_mfma_f32_16x16x32_bf16 v[144:147], v[92:95], v[128:131], v[144:147]
v_mfma_f32_16x16x32_bf16 v[148:151], v[92:95], v[132:135], v[148:151]
s_waitcnt lgkmcnt(0)
s_barrier
ds_read_b128 v[120:123], v19 offset:16384
ds_read_b128 v[124:127], v19 offset:18432
ds_read_b128 v[128:131], v19 offset:20480
ds_read_b128 v[132:135], v19 offset:22528
v_mfma_f32_16x16x32_bf16 v[136:139], v[96:99], v[104:107], v[136:139]
v_mfma_f32_16x16x32_bf16 v[140:143], v[96:99], v[108:111], v[140:143]
v_mfma_f32_16x16x32_bf16 v[144:147], v[96:99], v[112:115], v[144:147]
v_mfma_f32_16x16x32_bf16 v[148:151], v[96:99], v[116:119], v[148:151]
s_waitcnt lgkmcnt(0)
v_mfma_f32_16x16x32_bf16 v[136:139], v[100:103], v[120:123], v[136:139]
v_mfma_f32_16x16x32_bf16 v[140:143], v[100:103], v[124:127], v[140:143]
v_mfma_f32_16x16x32_bf16 v[144:147], v[100:103], v[128:131], v[144:147]
v_mfma_f32_16x16x32_bf16 v[148:151], v[100:103], v[132:135], v[148:151]
s_lshl_b32 s9, s4, 7
s_lshl_b32 s10, s16, 6
s_add_u32 s9, s9, s10
v_add_u32 v5, s9, v3
v_lshlrev_b32 v5, 2, v5
v_mul_f32 v136, 0xbfb8aa3b, v136
v_exp_f32 v136, v136
s_nop 0
v_add_f32 v136, 1.0, v136
v_rcp_f32 v136, v136
v_mul_f32 v140, 0xbfb8aa3b, v140
v_exp_f32 v140, v140
s_nop 0
v_add_f32 v140, 1.0, v140
v_rcp_f32 v140, v140
v_mul_f32 v144, 0xbfb8aa3b, v144
v_exp_f32 v144, v144
s_nop 0
v_add_f32 v144, 1.0, v144
v_rcp_f32 v144, v144
v_mul_f32 v148, 0xbfb8aa3b, v148
v_exp_f32 v148, v148
s_nop 0
v_add_f32 v148, 1.0, v148
v_rcp_f32 v148, v148
v_cmp_gt_u32 vcc, 16, v2
s_nop 0
s_and_saveexec_b64 s[6:7], vcc
buffer_store_dword v136, v5, s[68:71], 0 offen offset:0
buffer_store_dword v140, v5, s[68:71], 0 offen offset:64
buffer_store_dword v144, v5, s[68:71], 0 offen offset:128
buffer_store_dword v148, v5, s[68:71], 0 offen offset:192
s_endpgm
K1_T:
s_sub_u32 s4, s2, 224
v_lshrrev_b32 v1, 6, v0
v_and_b32 v2, 63, v0
v_readfirstlane_b32 s8, v1
s_waitcnt lgkmcnt(0)
s_mov_b32 s48, s36
s_mov_b32 s49, s37
s_mov_b32 s50, 0x21c000
s_mov_b32 s51, 0x20000
s_add_u32 s52, s46, 0x700000
s_addc_u32 s53, s47, 0
s_mov_b32 s54, 0x21c000
s_mov_b32 s55, 0x20000
s_mov_b32 s56, s16
s_mov_b32 s57, s17
s_mov_b32 s58, 0x280000
s_mov_b32 s59, 0x20000
s_add_u32 s60, s46, 0xa00000
s_addc_u32 s61, s47, 0
s_mov_b32 s62, 0x280000
s_mov_b32 s63, 0x20000
s_add_u32 s64, s46, 0xf00000
s_addc_u32 s65, s47, 0
s_mov_b32 s66, 0x2000
s_mov_b32 s67, 0x20000
s_lshl_b32 s5, s4, 3
s_add_u32 s5, s5, s8
v_lshrrev_b32 v3, 3, v2
v_mul_u32_u24 v3, 1280, v3
v_and_b32 v4, 7, v2
v_lshl_add_u32 v10, v4, 4, v3
s_mul_i32 s9, s8, 20480
s_add_u32 s10, s5, 0
s_min_u32 s10, s10, 539
s_mul_i32 s11, s10, 52429
s_lshr_b32 s72, s11, 19
s_mul_i32 s11, s72, 10
s_sub_u32 s73, s10, s11
s_mul_i32 s12, s72, 40960
s_lshl_b32 s13, s73, 7
s_add_u32 s12, s12, s13
s_add_u32 m0, s9, 0
s_nop 0
buffer_load_dwordx4 v10, s[48:51], s12 offen lds
s_add_u32 s12, s12, 10240
s_add_u32 m0, s9, 1024
s_nop 0
buffer_load_dwordx4 v10, s[48:51], s12 offen lds
s_add_u32 s12, s12, 10240
s_add_u32 m0, s9, 2048
s_nop 0
buffer_load_dwordx4 v10, s[48:51], s12 offen lds
s_add_u32 s12, s12, 10240
s_add_u32 m0, s9, 3072
s_nop 0
buffer_load_dwordx4 v10, s[48:51], s12 offen lds
s_add_u32 s10, s5, 256
s_min_u32 s10, s10, 539
s_mul_i32 s11, s10, 52429
s_lshr_b32 s74, s11, 19
s_mul_i32 s11, s74, 10
s_sub_u32 s75, s10, s11
s_mul_i32 s12, s74, 40960
s_lshl_b32 s13, s75, 7
s_add_u32 s12, s12, s13
s_add_u32 m0, s9, 4096
s_nop 0
buffer_load_dwordx4 v10, s[48:51], s12 offen lds
s_add_u32 s12, s12, 10240
s_add_u32 m0, s9, 5120
s_nop 0
buffer_load_dwordx4 v10, s[48:51], s12 offen lds
s_add_u32 s12, s12, 10240
s_add_u32 m0, s9, 6144
s_nop 0
buffer_load_dwordx4 v10, s[48:51], s12 offen lds
s_add_u32 s12, s12, 10240
s_add_u32 m0, s9, 7168
s_nop 0
buffer_load_dwordx4 v10, s[48:51], s12 offen lds
s_add_u32 s10, s5, 512
s_min_u32 s10, s10, 539
s_mul_i32 s11, s10, 52429
s_lshr_b32 s76, s11, 19
s_mul_i32 s11, s76, 10
s_sub_u32 s77, s10, s11
s_mul_i32 s12, s76, 40960
s_lshl_b32 s13, s77, 7
s_add_u32 s12, s12, s13
s_add_u32 m0, s9, 8192
s_nop 0
buffer_load_dwordx4 v10, s[48:51], s12 offen lds
s_add_u32 s12, s12, 10240
s_add_u32 m0, s9, 9216
s_nop 0
buffer_load_dwordx4 v10, s[48:51], s12 offen lds
s_add_u32 s12, s12, 10240
s_add_u32 m0, s9, 10240
s_nop 0
buffer_load_dwordx4 v10, s[48:51], s12 offen lds
s_add_u32 s12, s12, 10240
s_add_u32 m0, s9, 11264
s_nop 0
buffer_load_dwordx4 v10, s[48:51], s12 offen lds
v_lshlrev_b32 v12, 4, v2
s_add_u32 s68, s46, 0xf20000
s_addc_u32 s69, s47, 0
s_mov_b32 s70, 0x5000
s_mov_b32 s71, 0x20000
v_lshlrev_b32 v13, 2, v2
v_min_u32 v13, 124, v13
v_mov_b32 v14, 0
s_lshl_b32 s10, s5, 7
buffer_store_dword v14, v13, s[68:71], s10 offen sc1
s_cmp_lg_u32 s5, 0
s_cbranch_scc1 TCF_5
v_and_b32 v3, 15, v2
v_lshrrev_b32 v4, 4, v2
v_lshl_add_u32 v3, v4, 3, v3
v_lshlrev_b32 v12, 4, v2
v_mov_b32 v13, 0
v_mov_b32 v14, 0x3f80
v_mov_b32 v15, 0x3f800000
v_add_u32 v5, -21, v3
v_add_u32 v6, -20, v3
v_cmp_gt_u32 vcc, 5, v5
s_nop 1
v_cndmask_b32 v7, v13, v14, vcc
v_cmp_gt_u32 vcc, 5, v6
s_nop 1
v_cndmask_b32 v8, v13, v15, vcc
v_or_b32 v16, v7, v8
v_add_u32 v5, -19, v3
v_add_u32 v6, -18, v3
v_cmp_gt_u32 vcc, 5, v5
s_nop 1
v_cndmask_b32 v7, v13, v14, vcc
v_cmp_gt_u32 vcc, 5, v6
s_nop 1
v_cndmask_b32 v8, v13, v15, vcc
v_or_b32 v17, v7, v8
v_add_u32 v5, -17, v3
v_add_u32 v6, -16, v3
v_cmp_gt_u32 vcc, 5, v5
s_nop 1
v_cndmask_b32 v7, v13, v14, vcc
v_cmp_gt_u32 vcc, 5, v6
s_nop 1
v_cndmask_b32 v8, v13, v15, vcc
v_or_b32 v18, v7, v8
v_add_u32 v5, -15, v3
v_add_u32 v6, -14, v3
v_cmp_gt_u32 vcc, 5, v5
s_nop 1
v_cndmask_b32 v7, v13, v14, vcc
v_cmp_gt_u32 vcc, 5, v6
s_nop 1
v_cndmask_b32 v8, v13, v15, vcc
v_or_b32 v19, v7, v8
s_mov_b32 s10, 0
buffer_store_dwordx4 v[16:19], v12, s[64:67], s10 offen
s_nop 1
v_mov_b32 v14, 0x3f80
v_mov_b32 v15, 0x3f800000
v_add_u32 v5, -26, v3
v_add_u32 v6, -25, v3
v_cmp_gt_u32 vcc, 3, v5
s_nop 1
v_cndmask_b32 v7, v13, v14, vcc
v_cmp_gt_u32 vcc, 3, v6
s_nop 1
v_cndmask_b32 v8, v13, v15, vcc
v_or_b32 v16, v7, v8
v_add_u32 v5, -24, v3
v_add_u32 v6, -23, v3
v_cmp_gt_u32 vcc, 3, v5
s_nop 1
v_cndmask_b32 v7, v13, v14, vcc
v_cmp_gt_u32 vcc, 3, v6
s_nop 1
v_cndmask_b32 v8, v13, v15, vcc
v_or_b32 v17, v7, v8
v_add_u32 v5, -22, v3
v_add_u32 v6, -21, v3
v_cmp_gt_u32 vcc, 3, v5
s_nop 1
v_cndmask_b32 v7, v13, v14, vcc
v_cmp_gt_u32 vcc, 3, v6
s_nop 1
v_cndmask_b32 v8, v13, v15, vcc
v_or_b32 v18, v7, v8
v_add_u32 v5, -20, v3
v_add_u32 v6, -19, v3
v_cmp_gt_u32 vcc, 3, v5
s_nop 1
v_cndmask_b32 v7, v13, v14, vcc
v_cmp_gt_u32 vcc, 3, v6
s_nop 1
v_cndmask_b32 v8, v13, v15, vcc
v_or_b32 v19, v7, v8
s_mov_b32 s10, 1024
buffer_store_dwordx4 v[16:19], v12, s[64:67], s10 offen
s_nop 1
v_mov_b32 v14, 0x3f80
v_mov_b32 v15, 0x3f800000
v_add_u32 v5, -20, v3
v_add_u32 v6, -19, v3
v_cmp_gt_u32 vcc, 7, v5
s_nop 1
v_cndmask_b32 v7, v13, v14, vcc
v_cmp_gt_u32 vcc, 7, v6
s_nop 1
v_cndmask_b32 v8, v13, v15, vcc
v_or_b32 v16, v7, v8
v_add_u32 v5, -18, v3
v_add_u32 v6, -17, v3
v_cmp_gt_u32 vcc, 7, v5
s_nop 1
v_cndmask_b32 v7, v13, v14, vcc
v_cmp_gt_u32 vcc, 7, v6
s_nop 1
v_cndmask_b32 v8, v13, v15, vcc
v_or_b32 v17, v7, v8
v_add_u32 v5, -16, v3
v_add_u32 v6, -15, v3
v_cmp_gt_u32 vcc, 7, v5
s_nop 1
v_cndmask_b32 v7, v13, v14, vcc
v_cmp_gt_u32 vcc, 7, v6
s_nop 1
v_cndmask_b32 v8, v13, v15, vcc
v_or_b32 v18, v7, v8
v_add_u32 v5, -14, v3
v_add_u32 v6, -13, v3
v_cmp_gt_u32 vcc, 7, v5
s_nop 1
v_cndmask_b32 v7, v13, v14, vcc
v_cmp_gt_u32 vcc, 7, v6
s_nop 1
v_cndmask_b32 v8, v13, v15, vcc
v_or_b32 v19, v7, v8
s_mov_b32 s10, 2048
buffer_store_dwordx4 v[16:19], v12, s[64:67], s10 offen
s_nop 1
v_mov_b32 v14, 0x3f80
v_mov_b32 v15, 0x3f800000
v_add_u32 v5, -21, v3
v_add_u32 v6, -20, v3
v_cmp_gt_u32 vcc, 5, v5
s_nop 1
v_cndmask_b32 v7, v13, v14, vcc
v_cmp_gt_u32 vcc, 5, v6
s_nop 1
v_cndmask_b32 v8, v13, v15, vcc
v_or_b32 v16, v7, v8
v_add_u32 v5, -19, v3
v_add_u32 v6, -18, v3
v_cmp_gt_u32 vcc, 5, v5
s_nop 1
v_cndmask_b32 v7, v13, v14, vcc
v_cmp_gt_u32 vcc, 5, v6
s_nop 1
v_cndmask_b32 v8, v13, v15, vcc
v_or_b32 v17, v7, v8
v_add_u32 v5, -17, v3
v_add_u32 v6, -16, v3
v_cmp_gt_u32 vcc, 5, v5
s_nop 1
v_cndmask_b32 v7, v13, v14, vcc
v_cmp_gt_u32 vcc, 5, v6
s_nop 1
v_cndmask_b32 v8, v13, v15, vcc
v_or_b32 v18, v7, v8
v_add_u32 v5, -15, v3
v_add_u32 v6, -14, v3
v_cmp_gt_u32 vcc, 5, v5
s_nop 1
v_cndmask_b32 v7, v13, v14, vcc
v_cmp_gt_u32 vcc, 5, v6
s_nop 1
v_cndmask_b32 v8, v13, v15, vcc
v_or_b32 v19, v7, v8
s_mov_b32 s10, 3072
buffer_store_dwordx4 v[16:19], v12, s[64:67], s10 offen
s_nop 1
v_mov_b32 v14, 0x3f80
v_mov_b32 v15, 0x3f800000
v_add_u32 v5, -26, v3
v_add_u32 v6, -25, v3
v_cmp_gt_u32 vcc, 3, v5
s_nop 1
v_cndmask_b32 v7, v13, v14, vcc
v_cmp_gt_u32 vcc, 3, v6
s_nop 1
v_cndmask_b32 v8, v13, v15, vcc
v_or_b32 v16, v7, v8
v_add_u32 v5, -24, v3
v_add_u32 v6, -23, v3
v_cmp_gt_u32 vcc, 3, v5
s_nop 1
v_cndmask_b32 v7, v13, v14, vcc
v_cmp_gt_u32 vcc, 3, v6
s_nop 1
v_cndmask_b32 v8, v13, v15, vcc
v_or_b32 v17, v7, v8
v_add_u32 v5, -22, v3
v_add_u32 v6, -21, v3
v_cmp_gt_u32 vcc, 3, v5
s_nop 1
v_cndmask_b32 v7, v13, v14, vcc
v_cmp_gt_u32 vcc, 3, v6
s_nop 1
v_cndmask_b32 v8, v13, v15, vcc
v_or_b32 v18, v7, v8
v_add_u32 v5, -20, v3
v_add_u32 v6, -19, v3
v_cmp_gt_u32 vcc, 3, v5
s_nop 1
v_cndmask_b32 v7, v13, v14, vcc
v_cmp_gt_u32 vcc, 3, v6
s_nop 1
v_cndmask_b32 v8, v13, v15, vcc
v_or_b32 v19, v7, v8
s_mov_b32 s10, 4096
buffer_store_dwordx4 v[16:19], v12, s[64:67], s10 offen
s_nop 1
v_mov_b32 v14, 0x3f80
v_mov_b32 v15, 0x3f800000
v_add_u32 v5, -19, v3
v_add_u32 v6, -18, v3
v_cmp_gt_u32 vcc, 9, v5
s_nop 1
v_cndmask_b32 v7, v13, v14, vcc
v_cmp_gt_u32 vcc, 9, v6
s_nop 1
v_cndmask_b32 v8, v13, v15, vcc
v_or_b32 v16, v7, v8
v_add_u32 v5, -17, v3
v_add_u32 v6, -16, v3
v_cmp_gt_u32 vcc, 9, v5
s_nop 1
v_cndmask_b32 v7, v13, v14, vcc
v_cmp_gt_u32 vcc, 9, v6
s_nop 1
v_cndmask_b32 v8, v13, v15, vcc
v_or_b32 v17, v7, v8
v_add_u32 v5, -15, v3
v_add_u32 v6, -14, v3
v_cmp_gt_u32 vcc, 9, v5
s_nop 1
v_cndmask_b32 v7, v13, v14, vcc
v_cmp_gt_u32 vcc, 9, v6
s_nop 1
v_cndmask_b32 v8, v13, v15, vcc
v_or_b32 v18, v7, v8
v_add_u32 v5, -13, v3
v_add_u32 v6, -12, v3
v_cmp_gt_u32 vcc, 9, v5
s_nop 1
v_cndmask_b32 v7, v13, v14, vcc
v_cmp_gt_u32 vcc, 9, v6
s_nop 1
v_cndmask_b32 v8, v13, v15, vcc
v_or_b32 v19, v7, v8
s_mov_b32 s10, 5120
buffer_store_dwordx4 v[16:19], v12, s[64:67], s10 offen
s_nop 1
v_mov_b32 v14, 0xffff
v_mov_b32 v15, 0xffff0000
v_add_u32 v5, -18, v3
v_add_u32 v6, -17, v3
v_cmp_gt_u32 vcc, 2, v5
s_nop 1
v_cndmask_b32 v7, v13, v14, vcc
v_cmp_gt_u32 vcc, 2, v6
s_nop 1
v_cndmask_b32 v8, v13, v15, vcc
v_or_b32 v16, v7, v8
v_add_u32 v5, -16, v3
v_add_u32 v6, -15, v3
v_cmp_gt_u32 vcc, 2, v5
s_nop 1
v_cndmask_b32 v7, v13, v14, vcc
v_cmp_gt_u32 vcc, 2, v6
s_nop 1
v_cndmask_b32 v8, v13, v15, vcc
v_or_b32 v17, v7, v8
v_add_u32 v5, -14, v3
v_add_u32 v6, -13, v3
v_cmp_gt_u32 vcc, 2, v5
s_nop 1
v_cndmask_b32 v7, v13, v14, vcc
v_cmp_gt_u32 vcc, 2, v6
s_nop 1
v_cndmask_b32 v8, v13, v15, vcc
v_or_b32 v18, v7, v8
v_add_u32 v5, -12, v3
v_add_u32 v6, -11, v3
v_cmp_gt_u32 vcc, 2, v5
s_nop 1
v_cndmask_b32 v7, v13, v14, vcc
v_cmp_gt_u32 vcc, 2, v6
s_nop 1
v_cndmask_b32 v8, v13, v15, vcc
v_or_b32 v19, v7, v8
s_mov_b32 s10, 6144
buffer_store_dwordx4 v[16:19], v12, s[64:67], s10 offen
s_nop 1
TCF_5:
v_lshrrev_b32 v3, 4, v2
v_bfe_u32 v4, v2, 2, 2
v_and_b32 v5, 3, v2
v_lshl_add_u32 v6, v3, 2, v4
v_lshlrev_b32 v6, 7, v6
v_lshl_add_u32 v6, v5, 3, v6
v_add_u32 v11, s9, v6
v_lshlrev_b32 v12, 4, v2
s_waitcnt vmcnt(9)
ds_read_b64_tr_b16 v[16:17], v11 offset:0
ds_read_b64_tr_b16 v[18:19], v11 offset:2048
ds_read_b64_tr_b16 v[20:21], v11 offset:32
ds_read_b64_tr_b16 v[22:23], v11 offset:2080
ds_read_b64_tr_b16 v[24:25], v11 offset:64
ds_read_b64_tr_b16 v[26:27], v11 offset:2112
ds_read_b64_tr_b16 v[28:29], v11 offset:96
ds_read_b64_tr_b16 v[30:31], v11 offset:2144
s_lshl_b32 s10, s73, 2
s_add_u32 s10, s10, 0
s_mul_i32 s11, s10, 13
s_lshr_b32 s11, s11, 6
s_mul_i32 s12, s11, 5
s_sub_u32 s12, s10, s12
s_mul_i32 s11, s11, 54
s_add_u32 s11, s11, s72
s_mul_i32 s11, s11, 5
s_add_u32 s11, s11, s12
s_lshl_b32 s11, s11, 10
s_waitcnt lgkmcnt(6)
buffer_store_dwordx4 v[16:19], v12, s[52:55], s11 offen sc1
s_lshl_b32 s10, s73, 2
s_add_u32 s10, s10, 1
s_mul_i32 s11, s10, 13
s_lshr_b32 s11, s11, 6
s_mul_i32 s12, s11, 5
s_sub_u32 s12, s10, s12
s_mul_i32 s11, s11, 54
s_add_u32 s11, s11, s72
s_mul_i32 s11, s11, 5
s_add_u32 s11, s11, s12
s_lshl_b32 s11, s11, 10
s_waitcnt lgkmcnt(4)
buffer_store_dwordx4 v[20:23], v12, s[52:55], s11 offen sc1
s_lshl_b32 s10, s73, 2
s_add_u32 s10, s10, 2
s_mul_i32 s11, s10, 13
s_lshr_b32 s11, s11, 6
s_mul_i32 s12, s11, 5
s_sub_u32 s12, s10, s12
s_mul_i32 s11, s11, 54
s_add_u32 s11, s11, s72
s_mul_i32 s11, s11, 5
s_add_u32 s11, s11, s12
s_lshl_b32 s11, s11, 10
s_waitcnt lgkmcnt(2)
buffer_store_dwordx4 v[24:27], v12, s[52:55], s11 offen sc1
s_lshl_b32 s10, s73, 2
s_add_u32 s10, s10, 3
s_mul_i32 s11, s10, 13
s_lshr_b32 s11, s11, 6
s_mul_i32 s12, s11, 5
s_sub_u32 s12, s10, s12
s_mul_i32 s11, s11, 54
s_add_u32 s11, s11, s72
s_mul_i32 s11, s11, 5
s_add_u32 s11, s11, s12
s_lshl_b32 s11, s11, 10
s_waitcnt lgkmcnt(0)
buffer_store_dwordx4 v[28:31], v12, s[52:55], s11 offen sc1
s_waitcnt vmcnt(9)
ds_read_b64_tr_b16 v[32:33], v11 offset:4096
ds_read_b64_tr_b16 v[34:35], v11 offset:6144
ds_read_b64_tr_b16 v[36:37], v11 offset:4128
ds_read_b64_tr_b16 v[38:39], v11 offset:6176
ds_read_b64_tr_b16 v[40:41], v11 offset:4160
ds_read_b64_tr_b16 v[42:43], v11 offset:6208
ds_read_b64_tr_b16 v[44:45], v11 offset:4192
ds_read_b64_tr_b16 v[46:47], v11 offset:6240
s_lshl_b32 s10, s75, 2
s_add_u32 s10, s10, 0
s_mul_i32 s11, s10, 13
s_lshr_b32 s11, s11, 6
s_mul_i32 s12, s11, 5
s_sub_u32 s12, s10, s12
s_mul_i32 s11, s11, 54
s_add_u32 s11, s11, s74
s_mul_i32 s11, s11, 5
s_add_u32 s11, s11, s12
s_lshl_b32 s11, s11, 10
s_waitcnt lgkmcnt(6)
buffer_store_dwordx4 v[32:35], v12, s[52:55], s11 offen sc1
s_lshl_b32 s10, s75, 2
s_add_u32 s10, s10, 1
s_mul_i32 s11, s10, 13
s_lshr_b32 s11, s11, 6
s_mul_i32 s12, s11, 5
s_sub_u32 s12, s10, s12
s_mul_i32 s11, s11, 54
s_add_u32 s11, s11, s74
s_mul_i32 s11, s11, 5
s_add_u32 s11, s11, s12
s_lshl_b32 s11, s11, 10
s_waitcnt lgkmcnt(4)
buffer_store_dwordx4 v[36:39], v12, s[52:55], s11 offen sc1
s_lshl_b32 s10, s75, 2
s_add_u32 s10, s10, 2
s_mul_i32 s11, s10, 13
s_lshr_b32 s11, s11, 6
s_mul_i32 s12, s11, 5
s_sub_u32 s12, s10, s12
s_mul_i32 s11, s11, 54
s_add_u32 s11, s11, s74
s_mul_i32 s11, s11, 5
s_add_u32 s11, s11, s12
s_lshl_b32 s11, s11, 10
s_waitcnt lgkmcnt(2)
buffer_store_dwordx4 v[40:43], v12, s[52:55], s11 offen sc1
s_lshl_b32 s10, s75, 2
s_add_u32 s10, s10, 3
s_mul_i32 s11, s10, 13
s_lshr_b32 s11, s11, 6
s_mul_i32 s12, s11, 5
s_sub_u32 s12, s10, s12
s_mul_i32 s11, s11, 54
s_add_u32 s11, s11, s74
s_mul_i32 s11, s11, 5
s_add_u32 s11, s11, s12
s_lshl_b32 s11, s11, 10
s_waitcnt lgkmcnt(0)
buffer_store_dwordx4 v[44:47], v12, s[52:55], s11 offen sc1
s_waitcnt vmcnt(9)
ds_read_b64_tr_b16 v[16:17], v11 offset:8192
ds_read_b64_tr_b16 v[18:19], v11 offset:10240
ds_read_b64_tr_b16 v[20:21], v11 offset:8224
ds_read_b64_tr_b16 v[22:23], v11 offset:10272
ds_read_b64_tr_b16 v[24:25], v11 offset:8256
ds_read_b64_tr_b16 v[26:27], v11 offset:10304
ds_read_b64_tr_b16 v[28:29], v11 offset:8288
ds_read_b64_tr_b16 v[30:31], v11 offset:10336
s_lshl_b32 s10, s77, 2
s_add_u32 s10, s10, 0
s_mul_i32 s11, s10, 13
s_lshr_b32 s11, s11, 6
s_mul_i32 s12, s11, 5
s_sub_u32 s12, s10, s12
s_mul_i32 s11, s11, 54
s_add_u32 s11, s11, s76
s_mul_i32 s11, s11, 5
s_add_u32 s11, s11, s12
s_lshl_b32 s11, s11, 10
s_waitcnt lgkmcnt(6)
buffer_store_dwordx4 v[16:19], v12, s[52:55], s11 offen sc1
s_lshl_b32 s10, s77, 2
s_add_u32 s10, s10, 1
s_mul_i32 s11, s10, 13
s_lshr_b32 s11, s11, 6
s_mul_i32 s12, s11, 5
s_sub_u32 s12, s10, s12
s_mul_i32 s11, s11, 54
s_add_u32 s11, s11, s76
s_mul_i32 s11, s11, 5
s_add_u32 s11, s11, s12
s_lshl_b32 s11, s11, 10
s_waitcnt lgkmcnt(4)
buffer_store_dwordx4 v[20:23], v12, s[52:55], s11 offen sc1
s_lshl_b32 s10, s77, 2
s_add_u32 s10, s10, 2
s_mul_i32 s11, s10, 13
s_lshr_b32 s11, s11, 6
s_mul_i32 s12, s11, 5
s_sub_u32 s12, s10, s12
s_mul_i32 s11, s11, 54
s_add_u32 s11, s11, s76
s_mul_i32 s11, s11, 5
s_add_u32 s11, s11, s12
s_lshl_b32 s11, s11, 10
s_waitcnt lgkmcnt(2)
buffer_store_dwordx4 v[24:27], v12, s[52:55], s11 offen sc1
s_lshl_b32 s10, s77, 2
s_add_u32 s10, s10, 3
s_mul_i32 s11, s10, 13
s_lshr_b32 s11, s11, 6
s_mul_i32 s12, s11, 5
s_sub_u32 s12, s10, s12
s_mul_i32 s11, s11, 54
s_add_u32 s11, s11, s76
s_mul_i32 s11, s11, 5
s_add_u32 s11, s11, s12
s_lshl_b32 s11, s11, 10
s_waitcnt lgkmcnt(0)
buffer_store_dwordx4 v[28:31], v12, s[52:55], s11 offen sc1
s_endpgm
K1_END:
s_endpgm
.globl k2_kernel
.p2align 8
.type k2_kernel,@function
k2_kernel:
s_cmp_ge_u32 s2, 416
s_cbranch_scc1 K2_END
s_load_dwordx16 s[16:31], s[0:1], 0
s_load_dwordx16 s[32:47], s[0:1], 64
s_cmp_ge_u32 s2, 256
s_cbranch_scc1 K2_S
s_and_b32 s4, s2, 7
s_lshr_b32 s5, s2, 3
s_lshr_b32 s6, s5, 2
s_and_b32 s5, s5, 3
s_and_b32 s7, s4, 1
s_lshl_b32 s7, s7, 2
s_add_u32 s5, s5, s7
s_lshr_b32 s4, s4, 1
s_lshl_b32 s4, s4, 3
s_add_u32 s4, s4, s6
v_lshrrev_b32 v1, 6, v0
v_and_b32 v2, 63, v0
v_readfirstlane_b32 s8, v1
v_lshlrev_b32 v10, 4, v2
v_add_u32 v11, 4096, v10
s_waitcnt lgkmcnt(0)
s_mov_b32 s48, s46
s_mov_b32 s49, s47
s_mov_b32 s50, 0x6c0000
s_mov_b32 s51, 0x20000
s_add_u32 s52, s46, 0x700000
s_addc_u32 s53, s47, 0
s_mov_b32 s54, 0x21c000
s_mov_b32 s55, 0x20000
s_mul_i32 s9, s8, 14
s_cmp_eq_u32 s8, 3
s_cselect_b32 s10, 1, 0
s_sub_u32 s9, s9, s10
s_mul_i32 s11, s4, 54
s_add_u32 s11, s11, s9
s_lshl_b32 s11, s11, 12
s_mul_i32 s12, s5, 54
s_add_u32 s12, s12, s9
s_mul_i32 s12, s12, 5120
s_mov_b32 s3, 0
buffer_load_dwordx4 v[96:99], v10, s[52:55], s12 offen offset:0
buffer_load_dwordx4 v[100:103], v10, s[52:55], s12 offen offset:1024
buffer_load_dwordx4 v[104:107], v10, s[52:55], s12 offen offset:2048
buffer_load_dwordx4 v[108:111], v10, s[52:55], s12 offen offset:3072
buffer_load_dwordx4 v[112:115], v11, s[52:55], s12 offen offset:0
buffer_load_dwordx4 v[116:119], v10, s[48:51], s11 offen offset:0
buffer_load_dwordx4 v[120:123], v10, s[48:51], s11 offen offset:1024
buffer_load_dwordx4 v[124:127], v10, s[48:51], s11 offen offset:2048
buffer_load_dwordx4 v[128:131], v10, s[48:51], s11 offen offset:3072
s_add_u32 s11, s11, 4096
s_add_u32 s12, s12, 5120
buffer_load_dwordx4 v[132:135], v10, s[52:55], s12 offen offset:0
buffer_load_dwordx4 v[136:139], v10, s[52:55], s12 offen offset:1024
buffer_load_dwordx4 v[140:143], v10, s[52:55], s12 offen offset:2048
buffer_load_dwordx4 v[144:147], v10, s[52:55], s12 offen offset:3072
buffer_load_dwordx4 v[148:151], v11, s[52:55], s12 offen offset:0
buffer_load_dwordx4 v[152:155], v10, s[48:51], s11 offen offset:0
buffer_load_dwordx4 v[156:159], v10, s[48:51], s11 offen offset:1024
buffer_load_dwordx4 v[160:163], v10, s[48:51], s11 offen offset:2048
buffer_load_dwordx4 v[164:167], v10, s[48:51], s11 offen offset:3072
s_add_u32 s11, s11, 4096
s_add_u32 s12, s12, 5120
buffer_load_dwordx4 v[168:171], v10, s[52:55], s12 offen offset:0
buffer_load_dwordx4 v[172:175], v10, s[52:55], s12 offen offset:1024
buffer_load_dwordx4 v[176:179], v10, s[52:55], s12 offen offset:2048
buffer_load_dwordx4 v[180:183], v10, s[52:55], s12 offen offset:3072
buffer_load_dwordx4 v[184:187], v11, s[52:55], s12 offen offset:0
buffer_load_dwordx4 v[188:191], v10, s[48:51], s11 offen offset:0
buffer_load_dwordx4 v[192:195], v10, s[48:51], s11 offen offset:1024
buffer_load_dwordx4 v[196:199], v10, s[48:51], s11 offen offset:2048
buffer_load_dwordx4 v[200:203], v10, s[48:51], s11 offen offset:3072
s_add_u32 s11, s11, 4096
s_add_u32 s12, s12, 5120
s_mov_b32 s56, s42
s_mov_b32 s57, s43
s_mov_b32 s58, 0x280000
s_mov_b32 s59, 0x20000
s_mov_b32 s60, s38
s_mov_b32 s61, s39
s_mov_b32 s62, 0x500
s_mov_b32 s63, 0x20000
s_add_u32 s64, s46, 0xf10000
s_addc_u32 s65, s47, 0
s_mov_b32 s66, 0x2000
s_mov_b32 s67, 0x20000
s_add_u32 s68, s46, 0xf20000
s_addc_u32 s69, s47, 0
s_mov_b32 s70, 0x5000
s_mov_b32 s71, 0x20000
s_add_u32 s72, s46, 0x1000000
s_addc_u32 s73, s47, 0
s_mov_b32 s74, 0x280000
s_mov_b32 s75, 0x20000
v_lshrrev_b32 v3, 4, v2
v_and_b32 v4, 15, v2
s_mul_i32 s14, s5, 160
v_lshlrev_b32 v5, 3, v3
v_add_u32 v5, s14, v5
buffer_load_dwordx2 v[240:241], v5, s[60:63], 0 offen offset:0
buffer_load_dwordx2 v[242:243], v5, s[60:63], 0 offen offset:32
buffer_load_dwordx2 v[244:245], v5, s[60:63], 0 offen offset:64
buffer_load_dwordx2 v[246:247], v5, s[60:63], 0 offen offset:96
buffer_load_dwordx2 v[248:249], v5, s[60:63], 0 offen offset:128
s_lshl_b32 s15, s4, 6
s_lshl_b32 s14, s8, 4
s_add_u32 s15, s15, s14
v_add_u32 v6, s15, v4
v_lshlrev_b32 v7, 2, v6
buffer_load_dword v250, v7, s[64:67], 0 offen
v_mul_u32_u24 v6, 1280, v6
v_add_u32 v6, v6, v5
s_mul_i32 s13, s5, 2560
v_min_u32 v7, 19, v2
v_lshlrev_b32 v7, 7, v7
v_add_u32 v251, s13, v7
s_waitcnt vmcnt(24)
buffer_load_dwordx4 v[204:207], v10, s[52:55], s12 offen offset:0
buffer_load_dwordx4 v[208:211], v10, s[52:55], s12 offen offset:1024
buffer_load_dwordx4 v[212:215], v10, s[52:55], s12 offen offset:2048
buffer_load_dwordx4 v[216:219], v10, s[52:55], s12 offen offset:3072
buffer_load_dwordx4 v[220:223], v11, s[52:55], s12 offen offset:0
buffer_load_dwordx4 v[224:227], v10, s[48:51], s11 offen offset:0
buffer_load_dwordx4 v[228:231], v10, s[48:51], s11 offen offset:1024
buffer_load_dwordx4 v[232:235], v10, s[48:51], s11 offen offset:2048
buffer_load_dwordx4 v[236:239], v10, s[48:51], s11 offen offset:3072
v_mfma_f32_16x16x32_bf16 v[16:19], v[96:99], v[116:119], 0
v_mfma_f32_16x16x32_bf16 v[20:23], v[96:99], v[120:123], 0
v_mfma_f32_16x16x32_bf16 v[24:27], v[96:99], v[124:127], 0
v_mfma_f32_16x16x32_bf16 v[28:31], v[96:99], v[128:131], 0
v_mfma_f32_16x16x32_bf16 v[32:35], v[100:103], v[116:119], 0
v_mfma_f32_16x16x32_bf16 v[36:39], v[100:103], v[120:123], 0
v_mfma_f32_16x16x32_bf16 v[40:43], v[100:103], v[124:127], 0
v_mfma_f32_16x16x32_bf16 v[44:47], v[100:103], v[128:131], 0
v_mfma_f32_16x16x32_bf16 v[48:51], v[104:107], v[116:119], 0
v_mfma_f32_16x16x32_bf16 v[52:55], v[104:107], v[120:123], 0
v_mfma_f32_16x16x32_bf16 v[56:59], v[104:107], v[124:127], 0
v_mfma_f32_16x16x32_bf16 v[60:63], v[104:107], v[128:131], 0
v_mfma_f32_16x16x32_bf16 v[64:67], v[108:111], v[116:119], 0
v_mfma_f32_16x16x32_bf16 v[68:71], v[108:111], v[120:123], 0
v_mfma_f32_16x16x32_bf16 v[72:75], v[108:111], v[124:127], 0
v_mfma_f32_16x16x32_bf16 v[76:79], v[108:111], v[128:131], 0
v_mfma_f32_16x16x32_bf16 v[80:83], v[112:115], v[116:119], 0
v_mfma_f32_16x16x32_bf16 v[84:87], v[112:115], v[120:123], 0
v_mfma_f32_16x16x32_bf16 v[88:91], v[112:115], v[124:127], 0
v_mfma_f32_16x16x32_bf16 v[92:95], v[112:115], v[128:131], 0
s_add_u32 s11, s11, 4096
s_add_u32 s12, s12, 5120
s_waitcnt vmcnt(24)
buffer_load_dwordx4 v[96:99], v10, s[52:55], s12 offen offset:0
buffer_load_dwordx4 v[100:103], v10, s[52:55], s12 offen offset:1024
buffer_load_dwordx4 v[104:107], v10, s[52:55], s12 offen offset:2048
buffer_load_dwordx4 v[108:111], v10, s[52:55], s12 offen offset:3072
buffer_load_dwordx4 v[112:115], v11, s[52:55], s12 offen offset:0
buffer_load_dwordx4 v[116:119], v10, s[48:51], s11 offen offset:0
buffer_load_dwordx4 v[120:123], v10, s[48:51], s11 offen offset:1024
buffer_load_dwordx4 v[124:127], v10, s[48:51], s11 offen offset:2048
buffer_load_dwordx4 v[128:131], v10, s[48:51], s11 offen offset:3072
v_mfma_f32_16x16x32_bf16 v[16:19], v[132:135], v[152:155], v[16:19]
v_mfma_f32_16x16x32_bf16 v[20:23], v[132:135], v[156:159], v[20:23]
v_mfma_f32_16x16x32_bf16 v[24:27], v[132:135], v[160:163], v[24:27]
v_mfma_f32_16x16x32_bf16 v[28:31], v[132:135], v[164:167], v[28:31]
v_mfma_f32_16x16x32_bf16 v[32:35], v[136:139], v[152:155], v[32:35]
v_mfma_f32_16x16x32_bf16 v[36:39], v[136:139], v[156:159], v[36:39]
v_mfma_f32_16x16x32_bf16 v[40:43], v[136:139], v[160:163], v[40:43]
v_mfma_f32_16x16x32_bf16 v[44:47], v[136:139], v[164:167], v[44:47]
v_mfma_f32_16x16x32_bf16 v[48:51], v[140:143], v[152:155], v[48:51]
v_mfma_f32_16x16x32_bf16 v[52:55], v[140:143], v[156:159], v[52:55]
v_mfma_f32_16x16x32_bf16 v[56:59], v[140:143], v[160:163], v[56:59]
v_mfma_f32_16x16x32_bf16 v[60:63], v[140:143], v[164:167], v[60:63]
v_mfma_f32_16x16x32_bf16 v[64:67], v[144:147], v[152:155], v[64:67]
v_mfma_f32_16x16x32_bf16 v[68:71], v[144:147], v[156:159], v[68:71]
v_mfma_f32_16x16x32_bf16 v[72:75], v[144:147], v[160:163], v[72:75]
v_mfma_f32_16x16x32_bf16 v[76:79], v[144:147], v[164:167], v[76:79]
v_mfma_f32_16x16x32_bf16 v[80:83], v[148:151], v[152:155], v[80:83]
v_mfma_f32_16x16x32_bf16 v[84:87], v[148:151], v[156:159], v[84:87]
v_mfma_f32_16x16x32_bf16 v[88:91], v[148:151], v[160:163], v[88:91]
v_mfma_f32_16x16x32_bf16 v[92:95], v[148:151], v[164:167], v[92:95]
s_add_u32 s11, s11, 4096
s_add_u32 s12, s12, 5120
s_waitcnt vmcnt(24)
buffer_load_dwordx4 v[132:135], v10, s[52:55], s12 offen offset:0
buffer_load_dwordx4 v[136:139], v10, s[52:55], s12 offen offset:1024
buffer_load_dwordx4 v[140:143], v10, s[52:55], s12 offen offset:2048
buffer_load_dwordx4 v[144:147], v10, s[52:55], s12 offen offset:3072
buffer_load_dwordx4 v[148:151], v11, s[52:55], s12 offen offset:0
buffer_load_dwordx4 v[152:155], v10, s[48:51], s11 offen offset:0
buffer_load_dwordx4 v[156:159], v10, s[48:51], s11 offen offset:1024
buffer_load_dwordx4 v[160:163], v10, s[48:51], s11 offen offset:2048
buffer_load_dwordx4 v[164:167], v10, s[48:51], s11 offen offset:3072
v_mfma_f32_16x16x32_bf16 v[16:19], v[168:171], v[188:191], v[16:19]
v_mfma_f32_16x16x32_bf16 v[20:23], v[168:171], v[192:195], v[20:23]
v_mfma_f32_16x16x32_bf16 v[24:27], v[168:171], v[196:199], v[24:27]
v_mfma_f32_16x16x32_bf16 v[28:31], v[168:171], v[200:203], v[28:31]
v_mfma_f32_16x16x32_bf16 v[32:35], v[172:175], v[188:191], v[32:35]
v_mfma_f32_16x16x32_bf16 v[36:39], v[172:175], v[192:195], v[36:39]
v_mfma_f32_16x16x32_bf16 v[40:43], v[172:175], v[196:199], v[40:43]
v_mfma_f32_16x16x32_bf16 v[44:47], v[172:175], v[200:203], v[44:47]
v_mfma_f32_16x16x32_bf16 v[48:51], v[176:179], v[188:191], v[48:51]
v_mfma_f32_16x16x32_bf16 v[52:55], v[176:179], v[192:195], v[52:55]
v_mfma_f32_16x16x32_bf16 v[56:59], v[176:179], v[196:199], v[56:59]
v_mfma_f32_16x16x32_bf16 v[60:63], v[176:179], v[200:203], v[60:63]
v_mfma_f32_16x16x32_bf16 v[64:67], v[180:183], v[188:191], v[64:67]
v_mfma_f32_16x16x32_bf16 v[68:71], v[180:183], v[192:195], v[68:71]
v_mfma_f32_16x16x32_bf16 v[72:75], v[180:183], v[196:199], v[72:75]
v_mfma_f32_16x16x32_bf16 v[76:79], v[180:183], v[200:203], v[76:79]
v_mfma_f32_16x16x32_bf16 v[80:83], v[184:187], v[188:191], v[80:83]
v_mfma_f32_16x16x32_bf16 v[84:87], v[184:187], v[192:195], v[84:87]
v_mfma_f32_16x16x32_bf16 v[88:91], v[184:187], v[196:199], v[88:91]
v_mfma_f32_16x16x32_bf16 v[92:95], v[184:187], v[200:203], v[92:95]
s_add_u32 s11, s11, 4096
s_add_u32 s12, s12, 5120
s_waitcnt vmcnt(18)
buffer_load_dwordx4 v[168:171], v10, s[52:55], s12 offen offset:0
buffer_load_dwordx4 v[172:175], v10, s[52:55], s12 offen offset:1024
buffer_load_dwordx4 v[176:179], v10, s[52:55], s12 offen offset:2048
buffer_load_dwordx4 v[180:183], v10, s[52:55], s12 offen offset:3072
buffer_load_dwordx4 v[184:187], v11, s[52:55], s12 offen offset:0
buffer_load_dwordx4 v[188:191], v10, s[48:51], s11 offen offset:0
buffer_load_dwordx4 v[192:195], v10, s[48:51], s11 offen offset:1024
buffer_load_dwordx4 v[196:199], v10, s[48:51], s11 offen offset:2048
buffer_load_dwordx4 v[200:203], v10, s[48:51], s11 offen offset:3072
v_mfma_f32_16x16x32_bf16 v[16:19], v[204:207], v[224:227], v[16:19]
v_mfma_f32_16x16x32_bf16 v[20:23], v[204:207], v[228:231], v[20:23]
v_mfma_f32_16x16x32_bf16 v[24:27], v[204:207], v[232:235], v[24:27]
v_mfma_f32_16x16x32_bf16 v[28:31], v[204:207], v[236:239], v[28:31]
v_mfma_f32_16x16x32_bf16 v[32:35], v[208:211], v[224:227], v[32:35]
v_mfma_f32_16x16x32_bf16 v[36:39], v[208:211], v[228:231], v[36:39]
v_mfma_f32_16x16x32_bf16 v[40:43], v[208:211], v[232:235], v[40:43]
v_mfma_f32_16x16x32_bf16 v[44:47], v[208:211], v[236:239], v[44:47]
v_mfma_f32_16x16x32_bf16 v[48:51], v[212:215], v[224:227], v[48:51]
v_mfma_f32_16x16x32_bf16 v[52:55], v[212:215], v[228:231], v[52:55]
v_mfma_f32_16x16x32_bf16 v[56:59], v[212:215], v[232:235], v[56:59]
v_mfma_f32_16x16x32_bf16 v[60:63], v[212:215], v[236:239], v[60:63]
v_mfma_f32_16x16x32_bf16 v[64:67], v[216:219], v[224:227], v[64:67]
v_mfma_f32_16x16x32_bf16 v[68:71], v[216:219], v[228:231], v[68:71]
v_mfma_f32_16x16x32_bf16 v[72:75], v[216:219], v[232:235], v[72:75]
v_mfma_f32_16x16x32_bf16 v[76:79], v[216:219], v[236:239], v[76:79]
v_mfma_f32_16x16x32_bf16 v[80:83], v[220:223], v[224:227], v[80:83]
v_mfma_f32_16x16x32_bf16 v[84:87], v[220:223], v[228:231], v[84:87]
v_mfma_f32_16x16x32_bf16 v[88:91], v[220:223], v[232:235], v[88:91]
v_mfma_f32_16x16x32_bf16 v[92:95], v[220:223], v[236:239], v[92:95]
s_add_u32 s11, s11, 4096
s_add_u32 s12, s12, 5120
s_waitcnt vmcnt(18)
buffer_load_dwordx4 v[204:207], v10, s[52:55], s12 offen offset:0
buffer_load_dwordx4 v[208:211], v10, s[52:55], s12 offen offset:1024
buffer_load_dwordx4 v[212:215], v10, s[52:55], s12 offen offset:2048
buffer_load_dwordx4 v[216:219], v10, s[52:55], s12 offen offset:3072
buffer_load_dwordx4 v[220:223], v11, s[52:55], s12 offen offset:0
buffer_load_dwordx4 v[224:227], v10, s[48:51], s11 offen offset:0
buffer_load_dwordx4 v[228:231], v10, s[48:51], s11 offen offset:1024
buffer_load_dwordx4 v[232:235], v10, s[48:51], s11 offen offset:2048
buffer_load_dwordx4 v[236:239], v10, s[48:51], s11 offen offset:3072
v_mfma_f32_16x16x32_bf16 v[16:19], v[96:99], v[116:119], v[16:19]
v_mfma_f32_16x16x32_bf16 v[20:23], v[96:99], v[120:123], v[20:23]
v_mfma_f32_16x16x32_bf16 v[24:27], v[96:99], v[124:127], v[24:27]
v_mfma_f32_16x16x32_bf16 v[28:31], v[96:99], v[128:131], v[28:31]
v_mfma_f32_16x16x32_bf16 v[32:35], v[100:103], v[116:119], v[32:35]
v_mfma_f32_16x16x32_bf16 v[36:39], v[100:103], v[120:123], v[36:39]
v_mfma_f32_16x16x32_bf16 v[40:43], v[100:103], v[124:127], v[40:43]
v_mfma_f32_16x16x32_bf16 v[44:47], v[100:103], v[128:131], v[44:47]
v_mfma_f32_16x16x32_bf16 v[48:51], v[104:107], v[116:119], v[48:51]
v_mfma_f32_16x16x32_bf16 v[52:55], v[104:107], v[120:123], v[52:55]
v_mfma_f32_16x16x32_bf16 v[56:59], v[104:107], v[124:127], v[56:59]
v_mfma_f32_16x16x32_bf16 v[60:63], v[104:107], v[128:131], v[60:63]
v_mfma_f32_16x16x32_bf16 v[64:67], v[108:111], v[116:119], v[64:67]
v_mfma_f32_16x16x32_bf16 v[68:71], v[108:111], v[120:123], v[68:71]
v_mfma_f32_16x16x32_bf16 v[72:75], v[108:111], v[124:127], v[72:75]
v_mfma_f32_16x16x32_bf16 v[76:79], v[108:111], v[128:131], v[76:79]
v_mfma_f32_16x16x32_bf16 v[80:83], v[112:115], v[116:119], v[80:83]
v_mfma_f32_16x16x32_bf16 v[84:87], v[112:115], v[120:123], v[84:87]
v_mfma_f32_16x16x32_bf16 v[88:91], v[112:115], v[124:127], v[88:91]
v_mfma_f32_16x16x32_bf16 v[92:95], v[112:115], v[128:131], v[92:95]
s_add_u32 s11, s11, 4096
s_add_u32 s12, s12, 5120
s_waitcnt vmcnt(18)
buffer_load_dwordx4 v[96:99], v10, s[52:55], s12 offen offset:0
buffer_load_dwordx4 v[100:103], v10, s[52:55], s12 offen offset:1024
buffer_load_dwordx4 v[104:107], v10, s[52:55], s12 offen offset:2048
buffer_load_dwordx4 v[108:111], v10, s[52:55], s12 offen offset:3072
buffer_load_dwordx4 v[112:115], v11, s[52:55], s12 offen offset:0
buffer_load_dwordx4 v[116:119], v10, s[48:51], s11 offen offset:0
buffer_load_dwordx4 v[120:123], v10, s[48:51], s11 offen offset:1024
buffer_load_dwordx4 v[124:127], v10, s[48:51], s11 offen offset:2048
buffer_load_dwordx4 v[128:131], v10, s[48:51], s11 offen offset:3072
v_mfma_f32_16x16x32_bf16 v[16:19], v[132:135], v[152:155], v[16:19]
v_mfma_f32_16x16x32_bf16 v[20:23], v[132:135], v[156:159], v[20:23]
v_mfma_f32_16x16x32_bf16 v[24:27], v[132:135], v[160:163], v[24:27]
v_mfma_f32_16x16x32_bf16 v[28:31], v[132:135], v[164:167], v[28:31]
v_mfma_f32_16x16x32_bf16 v[32:35], v[136:139], v[152:155], v[32:35]
v_mfma_f32_16x16x32_bf16 v[36:39], v[136:139], v[156:159], v[36:39]
v_mfma_f32_16x16x32_bf16 v[40:43], v[136:139], v[160:163], v[40:43]
v_mfma_f32_16x16x32_bf16 v[44:47], v[136:139], v[164:167], v[44:47]
v_mfma_f32_16x16x32_bf16 v[48:51], v[140:143], v[152:155], v[48:51]
v_mfma_f32_16x16x32_bf16 v[52:55], v[140:143], v[156:159], v[52:55]
v_mfma_f32_16x16x32_bf16 v[56:59], v[140:143], v[160:163], v[56:59]
v_mfma_f32_16x16x32_bf16 v[60:63], v[140:143], v[164:167], v[60:63]
v_mfma_f32_16x16x32_bf16 v[64:67], v[144:147], v[152:155], v[64:67]
v_mfma_f32_16x16x32_bf16 v[68:71], v[144:147], v[156:159], v[68:71]
v_mfma_f32_16x16x32_bf16 v[72:75], v[144:147], v[160:163], v[72:75]
v_mfma_f32_16x16x32_bf16 v[76:79], v[144:147], v[164:167], v[76:79]
v_mfma_f32_16x16x32_bf16 v[80:83], v[148:151], v[152:155], v[80:83]
v_mfma_f32_16x16x32_bf16 v[84:87], v[148:151], v[156:159], v[84:87]
v_mfma_f32_16x16x32_bf16 v[88:91], v[148:151], v[160:163], v[88:91]
v_mfma_f32_16x16x32_bf16 v[92:95], v[148:151], v[164:167], v[92:95]
s_add_u32 s11, s11, 4096
s_add_u32 s12, s12, 5120
s_waitcnt vmcnt(18)
buffer_load_dwordx4 v[132:135], v10, s[52:55], s12 offen offset:0
buffer_load_dwordx4 v[136:139], v10, s[52:55], s12 offen offset:1024
buffer_load_dwordx4 v[140:143], v10, s[52:55], s12 offen offset:2048
buffer_load_dwordx4 v[144:147], v10, s[52:55], s12 offen offset:3072
buffer_load_dwordx4 v[148:151], v11, s[52:55], s12 offen offset:0
buffer_load_dwordx4 v[152:155], v10, s[48:51], s11 offen offset:0
buffer_load_dwordx4 v[156:159], v10, s[48:51], s11 offen offset:1024
buffer_load_dwordx4 v[160:163], v10, s[48:51], s11 offen offset:2048
buffer_load_dwordx4 v[164:167], v10, s[48:51], s11 offen offset:3072
v_mfma_f32_16x16x32_bf16 v[16:19], v[168:171], v[188:191], v[16:19]
v_mfma_f32_16x16x32_bf16 v[20:23], v[168:171], v[192:195], v[20:23]
v_mfma_f32_16x16x32_bf16 v[24:27], v[168:171], v[196:199], v[24:27]
v_mfma_f32_16x16x32_bf16 v[28:31], v[168:171], v[200:203], v[28:31]
v_mfma_f32_16x16x32_bf16 v[32:35], v[172:175], v[188:191], v[32:35]
v_mfma_f32_16x16x32_bf16 v[36:39], v[172:175], v[192:195], v[36:39]
v_mfma_f32_16x16x32_bf16 v[40:43], v[172:175], v[196:199], v[40:43]
v_mfma_f32_16x16x32_bf16 v[44:47], v[172:175], v[200:203], v[44:47]
v_mfma_f32_16x16x32_bf16 v[48:51], v[176:179], v[188:191], v[48:51]
v_mfma_f32_16x16x32_bf16 v[52:55], v[176:179], v[192:195], v[52:55]
v_mfma_f32_16x16x32_bf16 v[56:59], v[176:179], v[196:199], v[56:59]
v_mfma_f32_16x16x32_bf16 v[60:63], v[176:179], v[200:203], v[60:63]
v_mfma_f32_16x16x32_bf16 v[64:67], v[180:183], v[188:191], v[64:67]
v_mfma_f32_16x16x32_bf16 v[68:71], v[180:183], v[192:195], v[68:71]
v_mfma_f32_16x16x32_bf16 v[72:75], v[180:183], v[196:199], v[72:75]
v_mfma_f32_16x16x32_bf16 v[76:79], v[180:183], v[200:203], v[76:79]
v_mfma_f32_16x16x32_bf16 v[80:83], v[184:187], v[188:191], v[80:83]
v_mfma_f32_16x16x32_bf16 v[84:87], v[184:187], v[192:195], v[84:87]
v_mfma_f32_16x16x32_bf16 v[88:91], v[184:187], v[196:199], v[88:91]
v_mfma_f32_16x16x32_bf16 v[92:95], v[184:187], v[200:203], v[92:95]
s_add_u32 s11, s11, 4096
s_add_u32 s12, s12, 5120
s_waitcnt vmcnt(18)
buffer_load_dwordx4 v[168:171], v10, s[52:55], s12 offen offset:0
buffer_load_dwordx4 v[172:175], v10, s[52:55], s12 offen offset:1024
buffer_load_dwordx4 v[176:179], v10, s[52:55], s12 offen offset:2048
buffer_load_dwordx4 v[180:183], v10, s[52:55], s12 offen offset:3072
buffer_load_dwordx4 v[184:187], v11, s[52:55], s12 offen offset:0
buffer_load_dwordx4 v[188:191], v10, s[48:51], s11 offen offset:0
buffer_load_dwordx4 v[192:195], v10, s[48:51], s11 offen offset:1024
buffer_load_dwordx4 v[196:199], v10, s[48:51], s11 offen offset:2048
buffer_load_dwordx4 v[200:203], v10, s[48:51], s11 offen offset:3072
v_mfma_f32_16x16x32_bf16 v[16:19], v[204:207], v[224:227], v[16:19]
v_mfma_f32_16x16x32_bf16 v[20:23], v[204:207], v[228:231], v[20:23]
v_mfma_f32_16x16x32_bf16 v[24:27], v[204:207], v[232:235], v[24:27]
v_mfma_f32_16x16x32_bf16 v[28:31], v[204:207], v[236:239], v[28:31]
v_mfma_f32_16x16x32_bf16 v[32:35], v[208:211], v[224:227], v[32:35]
v_mfma_f32_16x16x32_bf16 v[36:39], v[208:211], v[228:231], v[36:39]
v_mfma_f32_16x16x32_bf16 v[40:43], v[208:211], v[232:235], v[40:43]
v_mfma_f32_16x16x32_bf16 v[44:47], v[208:211], v[236:239], v[44:47]
v_mfma_f32_16x16x32_bf16 v[48:51], v[212:215], v[224:227], v[48:51]
v_mfma_f32_16x16x32_bf16 v[52:55], v[212:215], v[228:231], v[52:55]
v_mfma_f32_16x16x32_bf16 v[56:59], v[212:215], v[232:235], v[56:59]
v_mfma_f32_16x16x32_bf16 v[60:63], v[212:215], v[236:239], v[60:63]
v_mfma_f32_16x16x32_bf16 v[64:67], v[216:219], v[224:227], v[64:67]
v_mfma_f32_16x16x32_bf16 v[68:71], v[216:219], v[228:231], v[68:71]
v_mfma_f32_16x16x32_bf16 v[72:75], v[216:219], v[232:235], v[72:75]
v_mfma_f32_16x16x32_bf16 v[76:79], v[216:219], v[236:239], v[76:79]
v_mfma_f32_16x16x32_bf16 v[80:83], v[220:223], v[224:227], v[80:83]
v_mfma_f32_16x16x32_bf16 v[84:87], v[220:223], v[228:231], v[84:87]
v_mfma_f32_16x16x32_bf16 v[88:91], v[220:223], v[232:235], v[88:91]
v_mfma_f32_16x16x32_bf16 v[92:95], v[220:223], v[236:239], v[92:95]
s_add_u32 s11, s11, 4096
s_add_u32 s12, s12, 5120
s_waitcnt vmcnt(18)
buffer_load_dwordx4 v[204:207], v10, s[52:55], s12 offen offset:0
buffer_load_dwordx4 v[208:211], v10, s[52:55], s12 offen offset:1024
buffer_load_dwordx4 v[212:215], v10, s[52:55], s12 offen offset:2048
buffer_load_dwordx4 v[216:219], v10, s[52:55], s12 offen offset:3072
buffer_load_dwordx4 v[220:223], v11, s[52:55], s12 offen offset:0
buffer_load_dwordx4 v[224:227], v10, s[48:51], s11 offen offset:0
buffer_load_dwordx4 v[228:231], v10, s[48:51], s11 offen offset:1024
buffer_load_dwordx4 v[232:235], v10, s[48:51], s11 offen offset:2048
buffer_load_dwordx4 v[236:239], v10, s[48:51], s11 offen offset:3072
v_mfma_f32_16x16x32_bf16 v[16:19], v[96:99], v[116:119], v[16:19]
v_mfma_f32_16x16x32_bf16 v[20:23], v[96:99], v[120:123], v[20:23]
v_mfma_f32_16x16x32_bf16 v[24:27], v[96:99], v[124:127], v[24:27]
v_mfma_f32_16x16x32_bf16 v[28:31], v[96:99], v[128:131], v[28:31]
v_mfma_f32_16x16x32_bf16 v[32:35], v[100:103], v[116:119], v[32:35]
v_mfma_f32_16x16x32_bf16 v[36:39], v[100:103], v[120:123], v[36:39]
v_mfma_f32_16x16x32_bf16 v[40:43], v[100:103], v[124:127], v[40:43]
v_mfma_f32_16x16x32_bf16 v[44:47], v[100:103], v[128:131], v[44:47]
v_mfma_f32_16x16x32_bf16 v[48:51], v[104:107], v[116:119], v[48:51]
v_mfma_f32_16x16x32_bf16 v[52:55], v[104:107], v[120:123], v[52:55]
v_mfma_f32_16x16x32_bf16 v[56:59], v[104:107], v[124:127], v[56:59]
v_mfma_f32_16x16x32_bf16 v[60:63], v[104:107], v[128:131], v[60:63]
v_mfma_f32_16x16x32_bf16 v[64:67], v[108:111], v[116:119], v[64:67]
v_mfma_f32_16x16x32_bf16 v[68:71], v[108:111], v[120:123], v[68:71]
v_mfma_f32_16x16x32_bf16 v[72:75], v[108:111], v[124:127], v[72:75]
v_mfma_f32_16x16x32_bf16 v[76:79], v[108:111], v[128:131], v[76:79]
v_mfma_f32_16x16x32_bf16 v[80:83], v[112:115], v[116:119], v[80:83]
v_mfma_f32_16x16x32_bf16 v[84:87], v[112:115], v[120:123], v[84:87]
v_mfma_f32_16x16x32_bf16 v[88:91], v[112:115], v[124:127], v[88:91]
v_mfma_f32_16x16x32_bf16 v[92:95], v[112:115], v[128:131], v[92:95]
s_add_u32 s11, s11, 4096
s_add_u32 s12, s12, 5120
s_waitcnt vmcnt(18)
buffer_load_dwordx4 v[96:99], v10, s[52:55], s12 offen offset:0
buffer_load_dwordx4 v[100:103], v10, s[52:55], s12 offen offset:1024
buffer_load_dwordx4 v[104:107], v10, s[52:55], s12 offen offset:2048
buffer_load_dwordx4 v[108:111], v10, s[52:55], s12 offen offset:3072
buffer_load_dwordx4 v[112:115], v11, s[52:55], s12 offen offset:0
buffer_load_dwordx4 v[116:119], v10, s[48:51], s11 offen offset:0
buffer_load_dwordx4 v[120:123], v10, s[48:51], s11 offen offset:1024
buffer_load_dwordx4 v[124:127], v10, s[48:51], s11 offen offset:2048
buffer_load_dwordx4 v[128:131], v10, s[48:51], s11 offen offset:3072
v_mfma_f32_16x16x32_bf16 v[16:19], v[132:135], v[152:155], v[16:19]
v_mfma_f32_16x16x32_bf16 v[20:23], v[132:135], v[156:159], v[20:23]
v_mfma_f32_16x16x32_bf16 v[24:27], v[132:135], v[160:163], v[24:27]
v_mfma_f32_16x16x32_bf16 v[28:31], v[132:135], v[164:167], v[28:31]
v_mfma_f32_16x16x32_bf16 v[32:35], v[136:139], v[152:155], v[32:35]
v_mfma_f32_16x16x32_bf16 v[36:39], v[136:139], v[156:159], v[36:39]
v_mfma_f32_16x16x32_bf16 v[40:43], v[136:139], v[160:163], v[40:43]
v_mfma_f32_16x16x32_bf16 v[44:47], v[136:139], v[164:167], v[44:47]
v_mfma_f32_16x16x32_bf16 v[48:51], v[140:143], v[152:155], v[48:51]
v_mfma_f32_16x16x32_bf16 v[52:55], v[140:143], v[156:159], v[52:55]
v_mfma_f32_16x16x32_bf16 v[56:59], v[140:143], v[160:163], v[56:59]
v_mfma_f32_16x16x32_bf16 v[60:63], v[140:143], v[164:167], v[60:63]
v_mfma_f32_16x16x32_bf16 v[64:67], v[144:147], v[152:155], v[64:67]
v_mfma_f32_16x16x32_bf16 v[68:71], v[144:147], v[156:159], v[68:71]
v_mfma_f32_16x16x32_bf16 v[72:75], v[144:147], v[160:163], v[72:75]
v_mfma_f32_16x16x32_bf16 v[76:79], v[144:147], v[164:167], v[76:79]
v_mfma_f32_16x16x32_bf16 v[80:83], v[148:151], v[152:155], v[80:83]
v_mfma_f32_16x16x32_bf16 v[84:87], v[148:151], v[156:159], v[84:87]
v_mfma_f32_16x16x32_bf16 v[88:91], v[148:151], v[160:163], v[88:91]
v_mfma_f32_16x16x32_bf16 v[92:95], v[148:151], v[164:167], v[92:95]
s_add_u32 s11, s11, 4096
s_add_u32 s12, s12, 5120
s_nop 5
s_cmp_eq_u32 s8, 3
s_cbranch_scc1 G2W3_2
s_waitcnt vmcnt(18)
buffer_load_dwordx4 v[132:135], v10, s[52:55], s12 offen offset:0
buffer_load_dwordx4 v[136:139], v10, s[52:55], s12 offen offset:1024
buffer_load_dwordx4 v[140:143], v10, s[52:55], s12 offen offset:2048
buffer_load_dwordx4 v[144:147], v10, s[52:55], s12 offen offset:3072
buffer_load_dwordx4 v[148:151], v11, s[52:55], s12 offen offset:0
buffer_load_dwordx4 v[152:155], v10, s[48:51], s11 offen offset:0
buffer_load_dwordx4 v[156:159], v10, s[48:51], s11 offen offset:1024
buffer_load_dwordx4 v[160:163], v10, s[48:51], s11 offen offset:2048
buffer_load_dwordx4 v[164:167], v10, s[48:51], s11 offen offset:3072
v_mfma_f32_16x16x32_bf16 v[16:19], v[168:171], v[188:191], v[16:19]
v_mfma_f32_16x16x32_bf16 v[20:23], v[168:171], v[192:195], v[20:23]
v_mfma_f32_16x16x32_bf16 v[24:27], v[168:171], v[196:199], v[24:27]
v_mfma_f32_16x16x32_bf16 v[28:31], v[168:171], v[200:203], v[28:31]
v_mfma_f32_16x16x32_bf16 v[32:35], v[172:175], v[188:191], v[32:35]
v_mfma_f32_16x16x32_bf16 v[36:39], v[172:175], v[192:195], v[36:39]
v_mfma_f32_16x16x32_bf16 v[40:43], v[172:175], v[196:199], v[40:43]
v_mfma_f32_16x16x32_bf16 v[44:47], v[172:175], v[200:203], v[44:47]
v_mfma_f32_16x16x32_bf16 v[48:51], v[176:179], v[188:191], v[48:51]
v_mfma_f32_16x16x32_bf16 v[52:55], v[176:179], v[192:195], v[52:55]
v_mfma_f32_16x16x32_bf16 v[56:59], v[176:179], v[196:199], v[56:59]
v_mfma_f32_16x16x32_bf16 v[60:63], v[176:179], v[200:203], v[60:63]
v_mfma_f32_16x16x32_bf16 v[64:67], v[180:183], v[188:191], v[64:67]
v_mfma_f32_16x16x32_bf16 v[68:71], v[180:183], v[192:195], v[68:71]
v_mfma_f32_16x16x32_bf16 v[72:75], v[180:183], v[196:199], v[72:75]
v_mfma_f32_16x16x32_bf16 v[76:79], v[180:183], v[200:203], v[76:79]
v_mfma_f32_16x16x32_bf16 v[80:83], v[184:187], v[188:191], v[80:83]
v_mfma_f32_16x16x32_bf16 v[84:87], v[184:187], v[192:195], v[84:87]
v_mfma_f32_16x16x32_bf16 v[88:91], v[184:187], v[196:199], v[88:91]
v_mfma_f32_16x16x32_bf16 v[92:95], v[184:187], v[200:203], v[92:95]
s_add_u32 s11, s11, 4096
s_add_u32 s12, s12, 5120
s_waitcnt vmcnt(18)
v_mfma_f32_16x16x32_bf16 v[16:19], v[204:207], v[224:227], v[16:19]
v_mfma_f32_16x16x32_bf16 v[20:23], v[204:207], v[228:231], v[20:23]
v_mfma_f32_16x16x32_bf16 v[24:27], v[204:207], v[232:235], v[24:27]
v_mfma_f32_16x16x32_bf16 v[28:31], v[204:207], v[236:239], v[28:31]
v_mfma_f32_16x16x32_bf16 v[32:35], v[208:211], v[224:227], v[32:35]
v_mfma_f32_16x16x32_bf16 v[36:39], v[208:211], v[228:231], v[36:39]
v_mfma_f32_16x16x32_bf16 v[40:43], v[208:211], v[232:235], v[40:43]
v_mfma_f32_16x16x32_bf16 v[44:47], v[208:211], v[236:239], v[44:47]
v_mfma_f32_16x16x32_bf16 v[48:51], v[212:215], v[224:227], v[48:51]
v_mfma_f32_16x16x32_bf16 v[52:55], v[212:215], v[228:231], v[52:55]
v_mfma_f32_16x16x32_bf16 v[56:59], v[212:215], v[232:235], v[56:59]
v_mfma_f32_16x16x32_bf16 v[60:63], v[212:215], v[236:239], v[60:63]
v_mfma_f32_16x16x32_bf16 v[64:67], v[216:219], v[224:227], v[64:67]
v_mfma_f32_16x16x32_bf16 v[68:71], v[216:219], v[228:231], v[68:71]
v_mfma_f32_16x16x32_bf16 v[72:75], v[216:219], v[232:235], v[72:75]
v_mfma_f32_16x16x32_bf16 v[76:79], v[216:219], v[236:239], v[76:79]
v_mfma_f32_16x16x32_bf16 v[80:83], v[220:223], v[224:227], v[80:83]
v_mfma_f32_16x16x32_bf16 v[84:87], v[220:223], v[228:231], v[84:87]
v_mfma_f32_16x16x32_bf16 v[88:91], v[220:223], v[232:235], v[88:91]
v_mfma_f32_16x16x32_bf16 v[92:95], v[220:223], v[236:239], v[92:95]
s_waitcnt vmcnt(9)
v_mfma_f32_16x16x32_bf16 v[16:19], v[96:99], v[116:119], v[16:19]
v_mfma_f32_16x16x32_bf16 v[20:23], v[96:99], v[120:123], v[20:23]
v_mfma_f32_16x16x32_bf16 v[24:27], v[96:99], v[124:127], v[24:27]
v_mfma_f32_16x16x32_bf16 v[28:31], v[96:99], v[128:131], v[28:31]
v_mfma_f32_16x16x32_bf16 v[32:35], v[100:103], v[116:119], v[32:35]
v_mfma_f32_16x16x32_bf16 v[36:39], v[100:103], v[120:123], v[36:39]
v_mfma_f32_16x16x32_bf16 v[40:43], v[100:103], v[124:127], v[40:43]
v_mfma_f32_16x16x32_bf16 v[44:47], v[100:103], v[128:131], v[44:47]
v_mfma_f32_16x16x32_bf16 v[48:51], v[104:107], v[116:119], v[48:51]
v_mfma_f32_16x16x32_bf16 v[52:55], v[104:107], v[120:123], v[52:55]
v_mfma_f32_16x16x32_bf16 v[56:59], v[104:107], v[124:127], v[56:59]
v_mfma_f32_16x16x32_bf16 v[60:63], v[104:107], v[128:131], v[60:63]
v_mfma_f32_16x16x32_bf16 v[64:67], v[108:111], v[116:119], v[64:67]
v_mfma_f32_16x16x32_bf16 v[68:71], v[108:111], v[120:123], v[68:71]
v_mfma_f32_16x16x32_bf16 v[72:75], v[108:111], v[124:127], v[72:75]
v_mfma_f32_16x16x32_bf16 v[76:79], v[108:111], v[128:131], v[76:79]
v_mfma_f32_16x16x32_bf16 v[80:83], v[112:115], v[116:119], v[80:83]
v_mfma_f32_16x16x32_bf16 v[84:87], v[112:115], v[120:123], v[84:87]
v_mfma_f32_16x16x32_bf16 v[88:91], v[112:115], v[124:127], v[88:91]
v_mfma_f32_16x16x32_bf16 v[92:95], v[112:115], v[128:131], v[92:95]
s_nop 7
s_cmp_ge_u32 s8, 2
s_cbranch_scc1 G2L_1
s_waitcnt vmcnt(0)
v_mfma_f32_16x16x32_bf16 v[16:19], v[132:135], v[152:155], v[16:19]
v_mfma_f32_16x16x32_bf16 v[20:23], v[132:135], v[156:159], v[20:23]
v_mfma_f32_16x16x32_bf16 v[24:27], v[132:135], v[160:163], v[24:27]
v_mfma_f32_16x16x32_bf16 v[28:31], v[132:135], v[164:167], v[28:31]
v_mfma_f32_16x16x32_bf16 v[32:35], v[136:139], v[152:155], v[32:35]
v_mfma_f32_16x16x32_bf16 v[36:39], v[136:139], v[156:159], v[36:39]
v_mfma_f32_16x16x32_bf16 v[40:43], v[136:139], v[160:163], v[40:43]
v_mfma_f32_16x16x32_bf16 v[44:47], v[136:139], v[164:167], v[44:47]
v_mfma_f32_16x16x32_bf16 v[48:51], v[140:143], v[152:155], v[48:51]
v_mfma_f32_16x16x32_bf16 v[52:55], v[140:143], v[156:159], v[52:55]
v_mfma_f32_16x16x32_bf16 v[56:59], v[140:143], v[160:163], v[56:59]
v_mfma_f32_16x16x32_bf16 v[60:63], v[140:143], v[164:167], v[60:63]
v_mfma_f32_16x16x32_bf16 v[64:67], v[144:147], v[152:155], v[64:67]
v_mfma_f32_16x16x32_bf16 v[68:71], v[144:147], v[156:159], v[68:71]
v_mfma_f32_16x16x32_bf16 v[72:75], v[144:147], v[160:163], v[72:75]
v_mfma_f32_16x16x32_bf16 v[76:79], v[144:147], v[164:167], v[76:79]
v_mfma_f32_16x16x32_bf16 v[80:83], v[148:151], v[152:155], v[80:83]
v_mfma_f32_16x16x32_bf16 v[84:87], v[148:151], v[156:159], v[84:87]
v_mfma_f32_16x16x32_bf16 v[88:91], v[148:151], v[160:163], v[88:91]
v_mfma_f32_16x16x32_bf16 v[92:95], v[148:151], v[164:167], v[92:95]
s_branch G2L_1
G2W3_2:
buffer_load_dword v252, v251, s[68:71], 0 offen sc1
s_waitcnt vmcnt(19)
v_mfma_f32_16x16x32_bf16 v[16:19], v[168:171], v[188:191], v[16:19]
v_mfma_f32_16x16x32_bf16 v[20:23], v[168:171], v[192:195], v[20:23]
v_mfma_f32_16x16x32_bf16 v[24:27], v[168:171], v[196:199], v[24:27]
v_mfma_f32_16x16x32_bf16 v[28:31], v[168:171], v[200:203], v[28:31]
v_mfma_f32_16x16x32_bf16 v[32:35], v[172:175], v[188:191], v[32:35]
v_mfma_f32_16x16x32_bf16 v[36:39], v[172:175], v[192:195], v[36:39]
v_mfma_f32_16x16x32_bf16 v[40:43], v[172:175], v[196:199], v[40:43]
v_mfma_f32_16x16x32_bf16 v[44:47], v[172:175], v[200:203], v[44:47]
v_mfma_f32_16x16x32_bf16 v[48:51], v[176:179], v[188:191], v[48:51]
v_mfma_f32_16x16x32_bf16 v[52:55], v[176:179], v[192:195], v[52:55]
v_mfma_f32_16x16x32_bf16 v[56:59], v[176:179], v[196:199], v[56:59]
v_mfma_f32_16x16x32_bf16 v[60:63], v[176:179], v[200:203], v[60:63]
v_mfma_f32_16x16x32_bf16 v[64:67], v[180:183], v[188:191], v[64:67]
v_mfma_f32_16x16x32_bf16 v[68:71], v[180:183], v[192:195], v[68:71]
v_mfma_f32_16x16x32_bf16 v[72:75], v[180:183], v[196:199], v[72:75]
v_mfma_f32_16x16x32_bf16 v[76:79], v[180:183], v[200:203], v[76:79]
v_mfma_f32_16x16x32_bf16 v[80:83], v[184:187], v[188:191], v[80:83]
v_mfma_f32_16x16x32_bf16 v[84:87], v[184:187], v[192:195], v[84:87]
v_mfma_f32_16x16x32_bf16 v[88:91], v[184:187], v[196:199], v[88:91]
v_mfma_f32_16x16x32_bf16 v[92:95], v[184:187], v[200:203], v[92:95]
s_waitcnt vmcnt(0)
v_cmp_ne_u32 vcc, 1, v252
s_mov_b32 s3, 0
s_nop 4
s_cbranch_vccnz G2NR_4
s_mov_b32 s3, 1
v_lshrrev_b32 v7, 3, v2
v_lshlrev_b32 v8, 12, v7
v_and_b32 v9, 7, v2
v_lshl_add_u32 v8, v9, 4, v8
s_mul_i32 s13, s5, 327680
s_lshl_b32 s14, s4, 7
s_add_u32 s13, s13, s14
buffer_load_dwordx4 v[132:135], v8, s[72:75], s13 offen sc1
s_add_u32 s13, s13, 32768
buffer_load_dwordx4 v[136:139], v8, s[72:75], s13 offen sc1
s_add_u32 s13, s13, 32768
buffer_load_dwordx4 v[140:143], v8, s[72:75], s13 offen sc1
s_add_u32 s13, s13, 32768
buffer_load_dwordx4 v[144:147], v8, s[72:75], s13 offen sc1
s_add_u32 s13, s13, 32768
buffer_load_dwordx4 v[148:151], v8, s[72:75], s13 offen sc1
s_add_u32 s13, s13, 32768
buffer_load_dwordx4 v[152:155], v8, s[72:75], s13 offen sc1
s_add_u32 s13, s13, 32768
buffer_load_dwordx4 v[156:159], v8, s[72:75], s13 offen sc1
s_add_u32 s13, s13, 32768
buffer_load_dwordx4 v[160:163], v8, s[72:75], s13 offen sc1
s_add_u32 s13, s13, 32768
buffer_load_dwordx4 v[164:167], v8, s[72:75], s13 offen sc1
s_add_u32 s13, s13, 32768
buffer_load_dwordx4 v[252:255], v8, s[72:75], s13 offen sc1
s_add_u32 s13, s13, 32768
G2NR_4:
v_mfma_f32_16x16x32_bf16 v[16:19], v[204:207], v[224:227], v[16:19]
v_mfma_f32_16x16x32_bf16 v[20:23], v[204:207], v[228:231], v[20:23]
v_mfma_f32_16x16x32_bf16 v[24:27], v[204:207], v[232:235], v[24:27]
v_mfma_f32_16x16x32_bf16 v[28:31], v[204:207], v[236:239], v[28:31]
v_mfma_f32_16x16x32_bf16 v[32:35], v[208:211], v[224:227], v[32:35]
v_mfma_f32_16x16x32_bf16 v[36:39], v[208:211], v[228:231], v[36:39]
v_mfma_f32_16x16x32_bf16 v[40:43], v[208:211], v[232:235], v[40:43]
v_mfma_f32_16x16x32_bf16 v[44:47], v[208:211], v[236:239], v[44:47]
v_mfma_f32_16x16x32_bf16 v[48:51], v[212:215], v[224:227], v[48:51]
v_mfma_f32_16x16x32_bf16 v[52:55], v[212:215], v[228:231], v[52:55]
v_mfma_f32_16x16x32_bf16 v[56:59], v[212:215], v[232:235], v[56:59]
v_mfma_f32_16x16x32_bf16 v[60:63], v[212:215], v[236:239], v[60:63]
v_mfma_f32_16x16x32_bf16 v[64:67], v[216:219], v[224:227], v[64:67]
v_mfma_f32_16x16x32_bf16 v[68:71], v[216:219], v[228:231], v[68:71]
v_mfma_f32_16x16x32_bf16 v[72:75], v[216:219], v[232:235], v[72:75]
v_mfma_f32_16x16x32_bf16 v[76:79], v[216:219], v[236:239], v[76:79]
v_mfma_f32_16x16x32_bf16 v[80:83], v[220:223], v[224:227], v[80:83]
v_mfma_f32_16x16x32_bf16 v[84:87], v[220:223], v[228:231], v[84:87]
v_mfma_f32_16x16x32_bf16 v[88:91], v[220:223], v[232:235], v[88:91]
v_mfma_f32_16x16x32_bf16 v[92:95], v[220:223], v[236:239], v[92:95]
v_mfma_f32_16x16x32_bf16 v[16:19], v[96:99], v[116:119], v[16:19]
v_mfma_f32_16x16x32_bf16 v[20:23], v[96:99], v[120:123], v[20:23]
v_mfma_f32_16x16x32_bf16 v[24:27], v[96:99], v[124:127], v[24:27]
v_mfma_f32_16x16x32_bf16 v[28:31], v[96:99], v[128:131], v[28:31]
v_mfma_f32_16x16x32_bf16 v[32:35], v[100:103], v[116:119], v[32:35]
v_mfma_f32_16x16x32_bf16 v[36:39], v[100:103], v[120:123], v[36:39]
v_mfma_f32_16x16x32_bf16 v[40:43], v[100:103], v[124:127], v[40:43]
v_mfma_f32_16x16x32_bf16 v[44:47], v[100:103], v[128:131], v[44:47]
v_mfma_f32_16x16x32_bf16 v[48:51], v[104:107], v[116:119], v[48:51]
v_mfma_f32_16x16x32_bf16 v[52:55], v[104:107], v[120:123], v[52:55]
v_mfma_f32_16x16x32_bf16 v[56:59], v[104:107], v[124:127], v[56:59]
v_mfma_f32_16x16x32_bf16 v[60:63], v[104:107], v[128:131], v[60:63]
v_mfma_f32_16x16x32_bf16 v[64:67], v[108:111], v[116:119], v[64:67]
v_mfma_f32_16x16x32_bf16 v[68:71], v[108:111], v[120:123], v[68:71]
v_mfma_f32_16x16x32_bf16 v[72:75], v[108:111], v[124:127], v[72:75]
v_mfma_f32_16x16x32_bf16 v[76:79], v[108:111], v[128:131], v[76:79]
v_mfma_f32_16x16x32_bf16 v[80:83], v[112:115], v[116:119], v[80:83]
v_mfma_f32_16x16x32_bf16 v[84:87], v[112:115], v[120:123], v[84:87]
v_mfma_f32_16x16x32_bf16 v[88:91], v[112:115], v[124:127], v[88:91]
v_mfma_f32_16x16x32_bf16 v[92:95], v[112:115], v[128:131], v[92:95]
s_cmp_eq_u32 s3, 0
s_cbranch_scc1 G2L_1
v_mul_u32_u24 v7, 160, v7
v_lshl_add_u32 v7, v9, 4, v7
v_add_u32 v7, 61440, v7
s_waitcnt vmcnt(9)
ds_write_b128 v7, v[132:135] offset:0
s_waitcnt vmcnt(8)
ds_write_b128 v7, v[136:139] offset:1280
s_waitcnt vmcnt(7)
ds_write_b128 v7, v[140:143] offset:2560
s_waitcnt vmcnt(6)
ds_write_b128 v7, v[144:147] offset:3840
s_waitcnt vmcnt(5)
ds_write_b128 v7, v[148:151] offset:5120
s_waitcnt vmcnt(4)
ds_write_b128 v7, v[152:155] offset:6400
s_waitcnt vmcnt(3)
ds_write_b128 v7, v[156:159] offset:7680
s_waitcnt vmcnt(2)
ds_write_b128 v7, v[160:163] offset:8960
s_waitcnt vmcnt(1)
ds_write_b128 v7, v[164:167] offset:10240
s_waitcnt vmcnt(0)
ds_write_b128 v7, v[252:255] offset:11520
G2L_1:
s_mul_i32 s13, s8, 15360
v_add_u32 v12, s13, v10
s_cmp_eq_u32 s8, 0
s_cbranch_scc1 G2S_5
s_cmp_lt_u32 s8, 0
s_cselect_b32 s14, 5120, 0
s_sub_u32 s14, 0, s14
v_add_u32 v13, s14, v12
ds_write_b128 v13, v[16:19] offset:0
ds_write_b128 v13, v[32:35] offset:1024
ds_write_b128 v13, v[48:51] offset:2048
ds_write_b128 v13, v[64:67] offset:3072
ds_write_b128 v13, v[80:83] offset:4096
G2S_5:
s_cmp_eq_u32 s8, 1
s_cbranch_scc1 G2S_6
s_cmp_lt_u32 s8, 1
s_cselect_b32 s14, 5120, 0
s_sub_u32 s14, 5120, s14
v_add_u32 v13, s14, v12
ds_write_b128 v13, v[20:23] offset:0
ds_write_b128 v13, v[36:39] offset:1024
ds_write_b128 v13, v[52:55] offset:2048
ds_write_b128 v13, v[68:71] offset:3072
ds_write_b128 v13, v[84:87] offset:4096
G2S_6:
s_cmp_eq_u32 s8, 2
s_cbranch_scc1 G2S_7
s_cmp_lt_u32 s8, 2
s_cselect_b32 s14, 5120, 0
s_sub_u32 s14, 10240, s14
v_add_u32 v13, s14, v12
ds_write_b128 v13, v[24:27] offset:0
ds_write_b128 v13, v[40:43] offset:1024
ds_write_b128 v13, v[56:59] offset:2048
ds_write_b128 v13, v[72:75] offset:3072
ds_write_b128 v13, v[88:91] offset:4096
G2S_7:
s_cmp_eq_u32 s8, 3
s_cbranch_scc1 G2S_8
s_cmp_lt_u32 s8, 3
s_cselect_b32 s14, 5120, 0
s_sub_u32 s14, 15360, s14
v_add_u32 v13, s14, v12
ds_write_b128 v13, v[28:31] offset:0
ds_write_b128 v13, v[44:47] offset:1024
ds_write_b128 v13, v[60:63] offset:2048
ds_write_b128 v13, v[76:79] offset:3072
ds_write_b128 v13, v[92:95] offset:4096
G2S_8:
s_cmp_lg_u32 s8, 3
s_cbranch_scc1 G2NA_9
s_cmp_eq_u32 s3, 1
s_cbranch_scc1 G2NA_9
s_mul_i32 s13, s5, 2560
v_min_u32 v7, 19, v2
v_lshlrev_b32 v7, 7, v7
v_add_u32 v7, s13, v7
v_mov_b32 v9, 1
s_mov_b32 s14, 0
G2POLL_10:
buffer_load_dword v8, v7, s[68:71], 0 offen sc1
s_waitcnt vmcnt(0)
v_cmp_ne_u32 vcc, v8, v9
s_nop 4
s_cbranch_vccz G2RDY_11
s_add_u32 s14, s14, 1
s_cmp_ge_u32 s14, 4096
s_cbranch_scc1 G2RDY_11
s_sleep 8
s_branch G2POLL_10
G2RDY_11:
v_lshrrev_b32 v7, 3, v2
v_lshlrev_b32 v8, 12, v7
v_and_b32 v9, 7, v2
v_lshl_add_u32 v8, v9, 4, v8
s_mul_i32 s13, s5, 327680
s_lshl_b32 s14, s4, 7
s_add_u32 s13, s13, s14
v_mul_u32_u24 v7, 160, v7
v_lshl_add_u32 v7, v9, 4, v7
v_add_u32 v7, 61440, v7
buffer_load_dwordx4 v[168:171], v8, s[72:75], s13 offen sc1
s_add_u32 s13, s13, 32768
buffer_load_dwordx4 v[172:175], v8, s[72:75], s13 offen sc1
s_add_u32 s13, s13, 32768
buffer_load_dwordx4 v[176:179], v8, s[72:75], s13 offen sc1
s_add_u32 s13, s13, 32768
buffer_load_dwordx4 v[180:183], v8, s[72:75], s13 offen sc1
s_add_u32 s13, s13, 32768
buffer_load_dwordx4 v[184:187], v8, s[72:75], s13 offen sc1
s_add_u32 s13, s13, 32768
buffer_load_dwordx4 v[188:191], v8, s[72:75], s13 offen sc1
s_add_u32 s13, s13, 32768
buffer_load_dwordx4 v[192:195], v8, s[72:75], s13 offen sc1
s_add_u32 s13, s13, 32768
buffer_load_dwordx4 v[196:199], v8, s[72:75], s13 offen sc1
s_add_u32 s13, s13, 32768
buffer_load_dwordx4 v[200:203], v8, s[72:75], s13 offen sc1
s_add_u32 s13, s13, 32768
buffer_load_dwordx4 v[204:207], v8, s[72:75], s13 offen sc1
s_add_u32 s13, s13, 32768
s_waitcnt vmcnt(9)
ds_write_b128 v7, v[168:171] offset:0
s_waitcnt vmcnt(8)
ds_write_b128 v7, v[172:175] offset:1280
s_waitcnt vmcnt(7)
ds_write_b128 v7, v[176:179] offset:2560
s_waitcnt vmcnt(6)
ds_write_b128 v7, v[180:183] offset:3840
s_waitcnt vmcnt(5)
ds_write_b128 v7, v[184:187] offset:5120
s_waitcnt vmcnt(4)
ds_write_b128 v7, v[188:191] offset:6400
s_waitcnt vmcnt(3)
ds_write_b128 v7, v[192:195] offset:7680
s_waitcnt vmcnt(2)
ds_write_b128 v7, v[196:199] offset:8960
s_waitcnt vmcnt(1)
ds_write_b128 v7, v[200:203] offset:10240
s_waitcnt vmcnt(0)
ds_write_b128 v7, v[204:207] offset:11520
G2NA_9:
s_waitcnt vmcnt(0)
s_waitcnt lgkmcnt(0)
s_barrier
s_cmp_lg_u32 s8, 0
s_cbranch_scc1 G2M_12
v_pk_add_f32 v[96:97], v[16:17], 0
v_pk_add_f32 v[98:99], v[18:19], 0
v_pk_add_f32 v[100:101], v[32:33], 0
v_pk_add_f32 v[102:103], v[34:35], 0
v_pk_add_f32 v[104:105], v[48:49], 0
v_pk_add_f32 v[106:107], v[50:51], 0
v_pk_add_f32 v[108:109], v[64:65], 0
v_pk_add_f32 v[110:111], v[66:67], 0
v_pk_add_f32 v[112:113], v[80:81], 0
v_pk_add_f32 v[114:115], v[82:83], 0
G2M_12:
s_cmp_lg_u32 s8, 1
s_cbranch_scc1 G2M_13
v_pk_add_f32 v[96:97], v[20:21], 0
v_pk_add_f32 v[98:99], v[22:23], 0
v_pk_add_f32 v[100:101], v[36:37], 0
v_pk_add_f32 v[102:103], v[38:39], 0
v_pk_add_f32 v[104:105], v[52:53], 0
v_pk_add_f32 v[106:107], v[54:55], 0
v_pk_add_f32 v[108:109], v[68:69], 0
v_pk_add_f32 v[110:111], v[70:71], 0
v_pk_add_f32 v[112:113], v[84:85], 0
v_pk_add_f32 v[114:115], v[86:87], 0
G2M_13:
s_cmp_lg_u32 s8, 2
s_cbranch_scc1 G2M_14
v_pk_add_f32 v[96:97], v[24:25], 0
v_pk_add_f32 v[98:99], v[26:27], 0
v_pk_add_f32 v[100:101], v[40:41], 0
v_pk_add_f32 v[102:103], v[42:43], 0
v_pk_add_f32 v[104:105], v[56:57], 0
v_pk_add_f32 v[106:107], v[58:59], 0
v_pk_add_f32 v[108:109], v[72:73], 0
v_pk_add_f32 v[110:111], v[74:75], 0
v_pk_add_f32 v[112:113], v[88:89], 0
v_pk_add_f32 v[114:115], v[90:91], 0
G2M_14:
s_cmp_lg_u32 s8, 3
s_cbranch_scc1 G2M_15
v_pk_add_f32 v[96:97], v[28:29], 0
v_pk_add_f32 v[98:99], v[30:31], 0
v_pk_add_f32 v[100:101], v[44:45], 0
v_pk_add_f32 v[102:103], v[46:47], 0
v_pk_add_f32 v[104:105], v[60:61], 0
v_pk_add_f32 v[106:107], v[62:63], 0
v_pk_add_f32 v[108:109], v[76:77], 0
v_pk_add_f32 v[110:111], v[78:79], 0
v_pk_add_f32 v[112:113], v[92:93], 0
v_pk_add_f32 v[114:115], v[94:95], 0
G2M_15:
s_add_u32 s13, s8, 1
s_and_b32 s13, s13, 3
s_cmp_lt_u32 s8, s13
s_cselect_b32 s14, 0, 1
s_sub_u32 s14, s8, s14
s_mul_i32 s13, s13, 15360
s_mul_i32 s14, s14, 5120
s_add_u32 s13, s13, s14
v_add_u32 v13, s13, v10
s_add_u32 s13, s8, 2
s_and_b32 s13, s13, 3
s_cmp_lt_u32 s8, s13
s_cselect_b32 s14, 0, 1
s_sub_u32 s14, s8, s14
s_mul_i32 s13, s13, 15360
s_mul_i32 s14, s14, 5120
s_add_u32 s13, s13, s14
v_add_u32 v14, s13, v10
s_add_u32 s13, s8, 3
s_and_b32 s13, s13, 3
s_cmp_lt_u32 s8, s13
s_cselect_b32 s14, 0, 1
s_sub_u32 s14, s8, s14
s_mul_i32 s13, s13, 15360
s_mul_i32 s14, s14, 5120
s_add_u32 s13, s13, s14
v_add_u32 v15, s13, v10
s_nop 1
ds_read_b128 v[16:19], v13 offset:0
ds_read_b128 v[20:23], v13 offset:1024
ds_read_b128 v[24:27], v13 offset:2048
ds_read_b128 v[28:31], v13 offset:3072
ds_read_b128 v[32:35], v13 offset:4096
ds_read_b128 v[36:39], v14 offset:0
ds_read_b128 v[40:43], v14 offset:1024
ds_read_b128 v[44:47], v14 offset:2048
ds_read_b128 v[48:51], v14 offset:3072
ds_read_b128 v[52:55], v14 offset:4096
ds_read_b128 v[56:59], v15 offset:0
ds_read_b128 v[60:63], v15 offset:1024
ds_read_b128 v[64:67], v15 offset:2048
ds_read_b128 v[68:71], v15 offset:3072
ds_read_b128 v[72:75], v15 offset:4096
v_bfe_u32 v7, v2, 2, 2
v_lshl_add_u32 v7, v3, 2, v7
v_mul_u32_u24 v7, 160, v7
v_and_b32 v8, 3, v2
v_lshl_add_u32 v7, v8, 3, v7
s_lshl_b32 s14, s8, 5
s_add_u32 s14, s14, 61440
v_add_u32 v7, s14, v7
ds_read_b64_tr_b16 v[184:185], v7 offset:0
ds_read_b64_tr_b16 v[186:187], v7 offset:2560
ds_read_b64_tr_b16 v[188:189], v7 offset:5120
ds_read_b64_tr_b16 v[190:191], v7 offset:7680
ds_read_b64_tr_b16 v[192:193], v7 offset:10240
s_waitcnt lgkmcnt(15)
v_pk_add_f32 v[96:97], v[96:97], v[16:17]
v_pk_add_f32 v[98:99], v[98:99], v[18:19]
v_pk_add_f32 v[100:101], v[100:101], v[20:21]
v_pk_add_f32 v[102:103], v[102:103], v[22:23]
v_pk_add_f32 v[104:105], v[104:105], v[24:25]
v_pk_add_f32 v[106:107], v[106:107], v[26:27]
v_pk_add_f32 v[108:109], v[108:109], v[28:29]
v_pk_add_f32 v[110:111], v[110:111], v[30:31]
v_pk_add_f32 v[112:113], v[112:113], v[32:33]
v_pk_add_f32 v[114:115], v[114:115], v[34:35]
s_waitcnt lgkmcnt(10)
v_pk_add_f32 v[96:97], v[96:97], v[36:37]
v_pk_add_f32 v[98:99], v[98:99], v[38:39]
v_pk_add_f32 v[100:101], v[100:101], v[40:41]
v_pk_add_f32 v[102:103], v[102:103], v[42:43]
v_pk_add_f32 v[104:105], v[104:105], v[44:45]
v_pk_add_f32 v[106:107], v[106:107], v[46:47]
v_pk_add_f32 v[108:109], v[108:109], v[48:49]
v_pk_add_f32 v[110:111], v[110:111], v[50:51]
v_pk_add_f32 v[112:113], v[112:113], v[52:53]
v_pk_add_f32 v[114:115], v[114:115], v[54:55]
s_waitcnt lgkmcnt(5)
v_pk_add_f32 v[96:97], v[96:97], v[56:57]
v_pk_add_f32 v[98:99], v[98:99], v[58:59]
v_pk_add_f32 v[100:101], v[100:101], v[60:61]
v_pk_add_f32 v[102:103], v[102:103], v[62:63]
v_pk_add_f32 v[104:105], v[104:105], v[64:65]
v_pk_add_f32 v[106:107], v[106:107], v[66:67]
v_pk_add_f32 v[108:109], v[108:109], v[68:69]
v_pk_add_f32 v[110:111], v[110:111], v[70:71]
v_pk_add_f32 v[112:113], v[112:113], v[72:73]
v_pk_add_f32 v[114:115], v[114:115], v[74:75]
s_waitcnt lgkmcnt(0)
v_lshlrev_b32 v8, 16, v240
v_and_b32 v9, 0xffff0000, v240
v_add_f32 v96, v96, v8
v_add_f32 v97, v97, v9
v_lshlrev_b32 v8, 16, v184
v_and_b32 v9, 0xffff0000, v184
v_sub_f32 v8, v8, v96
v_sub_f32 v9, v9, v97
v_fmac_f32 v96, v250, v8
v_fmac_f32 v97, v250, v9
v_lshlrev_b32 v8, 16, v241
v_and_b32 v9, 0xffff0000, v241
v_add_f32 v98, v98, v8
v_add_f32 v99, v99, v9
v_lshlrev_b32 v8, 16, v185
v_and_b32 v9, 0xffff0000, v185
v_sub_f32 v8, v8, v98
v_sub_f32 v9, v9, v99
v_fmac_f32 v98, v250, v8
v_fmac_f32 v99, v250, v9
v_cvt_pk_bf16_f32 v136, v96, v97
v_cvt_pk_bf16_f32 v137, v98, v99
buffer_store_dwordx2 v[136:137], v6, s[56:59], 0 offen offset:0
v_lshlrev_b32 v8, 16, v242
v_and_b32 v9, 0xffff0000, v242
v_add_f32 v100, v100, v8
v_add_f32 v101, v101, v9
v_lshlrev_b32 v8, 16, v186
v_and_b32 v9, 0xffff0000, v186
v_sub_f32 v8, v8, v100
v_sub_f32 v9, v9, v101
v_fmac_f32 v100, v250, v8
v_fmac_f32 v101, v250, v9
v_lshlrev_b32 v8, 16, v243
v_and_b32 v9, 0xffff0000, v243
v_add_f32 v102, v102, v8
v_add_f32 v103, v103, v9
v_lshlrev_b32 v8, 16, v187
v_and_b32 v9, 0xffff0000, v187
v_sub_f32 v8, v8, v102
v_sub_f32 v9, v9, v103
v_fmac_f32 v102, v250, v8
v_fmac_f32 v103, v250, v9
v_cvt_pk_bf16_f32 v138, v100, v101
v_cvt_pk_bf16_f32 v139, v102, v103
buffer_store_dwordx2 v[138:139], v6, s[56:59], 0 offen offset:32
v_lshlrev_b32 v8, 16, v244
v_and_b32 v9, 0xffff0000, v244
v_add_f32 v104, v104, v8
v_add_f32 v105, v105, v9
v_lshlrev_b32 v8, 16, v188
v_and_b32 v9, 0xffff0000, v188
v_sub_f32 v8, v8, v104
v_sub_f32 v9, v9, v105
v_fmac_f32 v104, v250, v8
v_fmac_f32 v105, v250, v9
v_lshlrev_b32 v8, 16, v245
v_and_b32 v9, 0xffff0000, v245
v_add_f32 v106, v106, v8
v_add_f32 v107, v107, v9
v_lshlrev_b32 v8, 16, v189
v_and_b32 v9, 0xffff0000, v189
v_sub_f32 v8, v8, v106
v_sub_f32 v9, v9, v107
v_fmac_f32 v106, v250, v8
v_fmac_f32 v107, v250, v9
v_cvt_pk_bf16_f32 v140, v104, v105
v_cvt_pk_bf16_f32 v141, v106, v107
buffer_store_dwordx2 v[140:141], v6, s[56:59], 0 offen offset:64
v_lshlrev_b32 v8, 16, v246
v_and_b32 v9, 0xffff0000, v246
v_add_f32 v108, v108, v8
v_add_f32 v109, v109, v9
v_lshlrev_b32 v8, 16, v190
v_and_b32 v9, 0xffff0000, v190
v_sub_f32 v8, v8, v108
v_sub_f32 v9, v9, v109
v_fmac_f32 v108, v250, v8
v_fmac_f32 v109, v250, v9
v_lshlrev_b32 v8, 16, v247
v_and_b32 v9, 0xffff0000, v247
v_add_f32 v110, v110, v8
v_add_f32 v111, v111, v9
v_lshlrev_b32 v8, 16, v191
v_and_b32 v9, 0xffff0000, v191
v_sub_f32 v8, v8, v110
v_sub_f32 v9, v9, v111
v_fmac_f32 v110, v250, v8
v_fmac_f32 v111, v250, v9
v_cvt_pk_bf16_f32 v142, v108, v109
v_cvt_pk_bf16_f32 v143, v110, v111
buffer_store_dwordx2 v[142:143], v6, s[56:59], 0 offen offset:96
v_lshlrev_b32 v8, 16, v248
v_and_b32 v9, 0xffff0000, v248
v_add_f32 v112, v112, v8
v_add_f32 v113, v113, v9
v_lshlrev_b32 v8, 16, v192
v_and_b32 v9, 0xffff0000, v192
v_sub_f32 v8, v8, v112
v_sub_f32 v9, v9, v113
v_fmac_f32 v112, v250, v8
v_fmac_f32 v113, v250, v9
v_lshlrev_b32 v8, 16, v249
v_and_b32 v9, 0xffff0000, v249
v_add_f32 v114, v114, v8
v_add_f32 v115, v115, v9
v_lshlrev_b32 v8, 16, v193
v_and_b32 v9, 0xffff0000, v193
v_sub_f32 v8, v8, v114
v_sub_f32 v9, v9, v115
v_fmac_f32 v114, v250, v8
v_fmac_f32 v115, v250, v9
v_cvt_pk_bf16_f32 v144, v112, v113
v_cvt_pk_bf16_f32 v145, v114, v115
buffer_store_dwordx2 v[144:145], v6, s[56:59], 0 offen offset:128
s_endpgm
K2_S:
s_setprio 3
s_sub_u32 s4, s2, 256
v_lshrrev_b32 v1, 6, v0
v_and_b32 v2, 63, v0
v_readfirstlane_b32 s8, v1
v_and_b32 v3, 15, v2
v_lshrrev_b32 v4, 4, v2
s_lshl_b32 s4, s4, 2
s_add_u32 s4, s4, s8
s_mul_i32 s9, s8, 20480
v_lshlrev_b32 v7, 4, v2
s_waitcnt lgkmcnt(0)
s_add_u32 s68, s46, 0x1400000
s_addc_u32 s69, s47, 0
s_mov_b32 s70, 0x1e0000
s_mov_b32 s71, 0x20000
s_add_u32 s72, s46, 0xa00000
s_addc_u32 s73, s47, 0
s_mov_b32 s74, 0x280000
s_mov_b32 s75, 0x20000
s_add_u32 s76, s46, 0xf00000
s_addc_u32 s77, s47, 0
s_mov_b32 s78, 0x2000
s_mov_b32 s79, 0x20000
s_lshl_b32 s12, s4, 12
s_mul_i32 s11, s4, 3072
buffer_load_dwordx4 v[64:67], v7, s[68:71], s11 offen offset:0
buffer_load_dwordx4 v[68:71], v7, s[68:71], s11 offen offset:1024
buffer_load_dwordx4 v[72:75], v7, s[68:71], s11 offen offset:2048
s_lshl_b32 s14, s8, 11
s_add_u32 m0, s14, 12288
s_add_u32 s13, s14, 0
buffer_load_dwordx4 v7, s[76:79], s13 offen lds
s_add_u32 m0, s14, 13312
s_add_u32 s13, s14, 1024
buffer_load_dwordx4 v7, s[76:79], s13 offen lds
s_add_u32 m0, s9, 0
s_add_u32 s13, s12, 0
buffer_load_dwordx4 v7, s[72:75], s13 offen lds
s_add_u32 m0, s9, 1024
s_add_u32 s13, s12, 1024
buffer_load_dwordx4 v7, s[72:75], s13 offen lds
s_add_u32 m0, s9, 2048
s_add_u32 s13, s12, 2048
buffer_load_dwordx4 v7, s[72:75], s13 offen lds
s_add_u32 m0, s9, 3072
s_add_u32 s13, s12, 3072
buffer_load_dwordx4 v7, s[72:75], s13 offen lds
s_add_u32 s15, s9, 4096
s_waitcnt vmcnt(6)
v_mov_b32 v20, 0
v_mov_b32 v21, 0
v_mov_b32 v22, 0
v_mov_b32 v23, 0
v_add_u32 v24, s15, v7
ds_write_b128 v24, v[20:23] offset:0
ds_write_b128 v24, v[20:23] offset:1024
ds_write_b128 v24, v[20:23] offset:2048
v_cvt_pk_bf16_f32 v32, v68, v68
v_cvt_pk_bf16_f32 v33, v68, v69
v_cvt_pk_bf16_f32 v34, v69, v69
v_lshlrev_b32 v25, 4, v3
s_add_u32 s14, s9, 5660
v_add_u32 v25, s14, v25
v_subrev_u32 v26, 32, v2
v_cmp_gt_u32 vcc, 2, v26
s_nop 0
s_and_saveexec_b64 s[6:7], vcc
ds_write2_b32 v25, v32, v32 offset0:0 offset1:1
ds_write2_b32 v25, v33, v34 offset0:2 offset1:3
s_mov_b64 exec, s[6:7]
v_cvt_pk_bf16_f32 v32, v68, v68
v_cvt_pk_bf16_f32 v33, v69, v70
v_cvt_pk_bf16_f32 v34, v70, v70
v_cvt_pk_bf16_f32 v35, v71, v71
v_lshlrev_b32 v25, 8, v4
v_lshl_add_u32 v25, v3, 4, v25
s_add_u32 s14, s9, 5150
v_add_u32 v25, s14, v25
v_cmp_gt_u32 vcc, 32, v2
s_nop 0
s_and_saveexec_b64 s[6:7], vcc
ds_write_b16 v25, v32
ds_write_b64 v25, v[32:33] offset:2
ds_write_b32 v25, v34 offset:10
ds_write_b16 v25, v35 offset:14
s_mov_b64 exec, s[6:7]
v_cvt_pk_bf16_f32 v36, v64, v65
v_cvt_pk_bf16_f32 v37, v66, v67
v_lshrrev_b32 v25, 1, v4
v_lshlrev_b32 v25, 8, v25
v_lshl_add_u32 v25, v3, 4, v25
v_and_b32 v26, 1, v4
v_lshl_add_u32 v25, v26, 3, v25
s_add_u32 s14, s9, 4640
v_add_u32 v25, s14, v25
ds_write_b64 v25, v[36:37]
v_cvt_pk_bf16_f32 v32, v68, v69
v_cvt_pk_bf16_f32 v33, v70, v71
v_add_u32 v25, 1, v3
v_lshrrev_b32 v25, 1, v25
v_lshl_add_u32 v25, v4, 4, v25
v_subrev_u32 v25, 1, v25
v_sub_u32 v26, 71, v25
v_lshlrev_b32 v26, 2, v26
v_and_b32 v27, 1, v3
v_mov_b32 v29, 6080
v_mov_b32 v30, 5824
v_cmp_eq_u32 vcc, 1, v27
s_nop 1
v_cndmask_b32 v29, v29, v30, vcc
v_add_u32 v26, v26, v29
v_add_u32 v26, s9, v26
v_cmp_le_u32 vcc, 32, v2
s_nop 0
s_and_saveexec_b64 s[6:7], vcc
ds_write_b32 v26, v33
v_cmp_le_u32 vcc, 34, v2
s_nop 0
s_and_b64 exec, exec, vcc
ds_write_b32 v26, v32 offset:32
s_mov_b64 exec, s[6:7]
v_cvt_pk_bf16_f32 v32, v72, v72
v_cvt_pk_bf16_f32 v33, v73, v73
v_cvt_pk_bf16_f32 v34, v74, v74
v_cvt_pk_bf16_f32 v35, v75, v75
v_add_u32 v25, 1, v3
v_lshrrev_b32 v25, 1, v25
v_lshl_add_u32 v25, v4, 5, v25
v_sub_u32 v26, 40, v25
v_lshlrev_b32 v26, 2, v26
v_and_b32 v27, 1, v3
v_xor_b32 v27, 1, v27
v_lshl_add_u32 v26, v27, 1, v26
s_add_u32 s14, s9, 6336
v_add_u32 v26, s14, v26
v_cmp_gt_u32 vcc, 32, v2
s_nop 0
s_and_saveexec_b64 s[6:7], vcc
ds_write_b16 v26, v35 offset:0
ds_write_b16 v26, v34 offset:32
ds_write_b16 v26, v33 offset:64
v_cmp_lt_u32 vcc, 0, v2
s_nop 0
s_and_b64 exec, exec, vcc
ds_write_b16 v26, v32 offset:96
s_mov_b64 exec, s[6:7]
v_mov_b32 v26, 6144
v_mov_b32 v27, 6338
v_cmp_eq_u32 vcc, 32, v2
s_nop 1
v_cndmask_b32 v26, v26, v27, vcc
v_add_u32 v26, s9, v26
v_and_b32 v27, 31, v2
v_cmp_eq_u32 vcc, 0, v27
s_nop 0
s_and_saveexec_b64 s[6:7], vcc
ds_write_b16 v26, v32
s_mov_b64 exec, s[6:7]
v_readlane_b32 s5, v32, 0
v_lshlrev_b32 v12, 5, v3
v_lshlrev_b32 v13, 4, v4
v_sub_u32 v12, v13, v12
s_add_u32 s13, s9, 480
v_add_u32 v8, s13, v12
v_add_u32 v12, 1, v3
v_lshrrev_b32 v12, 1, v12
v_lshl_add_u32 v12, v4, 2, v12
v_lshlrev_b32 v12, 2, v12
v_and_b32 v13, 1, v3
v_mov_b32 v14, 7232
v_mov_b32 v15, 4608
v_cmp_eq_u32 vcc, 1, v13
s_nop 1
v_cndmask_b32 v14, v14, v15, vcc
v_add_u32 v12, v12, v14
v_add_u32 v9, s9, v12
v_add_u32 v10, 1024, v9
v_lshlrev_b32 v12, 2, v4
v_sub_u32 v12, v12, v3
v_add_u32 v12, 15, v12
v_lshlrev_b32 v12, 2, v12
s_add_u32 s13, s9, 5824
v_add_u32 v11, s13, v12
s_waitcnt vmcnt(4)
s_barrier
v_add_u32 v13, 12288, v7
ds_read_b128 v[200:203], v13 offset:0
ds_read_b128 v[204:207], v13 offset:1024
ds_read_b128 v[208:211], v13 offset:2048
ds_read_b128 v[212:215], v13 offset:3072
ds_read_b128 v[216:219], v13 offset:4096
ds_read_b128 v[220:223], v13 offset:5120
ds_read_b128 v[224:227], v13 offset:6144
s_add_u32 s13, s9, 4608
v_add_u32 v13, s13, v7
ds_read_b128 v[16:19], v13
ds_read_b32 v20, v13 offset:16
ds_read_b128 v[24:27], v13 offset:1024
ds_read_b32 v28, v13 offset:1040
s_waitcnt lgkmcnt(2)
v_alignbit_b32 v152, v17, v16, 16
v_alignbit_b32 v153, v18, v17, 16
v_alignbit_b32 v154, v19, v18, 16
v_alignbit_b32 v155, v20, v19, 16
ds_write_b128 v13, v[152:155] offset:2624
s_waitcnt lgkmcnt(1)
v_alignbit_b32 v156, v25, v24, 16
v_alignbit_b32 v157, v26, v25, 16
v_alignbit_b32 v158, v27, v26, 16
v_alignbit_b32 v159, v28, v27, 16
v_cmp_gt_u32 vcc, 8, v2
s_nop 0
s_and_saveexec_b64 s[6:7], vcc
ds_write_b128 v13, v[156:159] offset:3648
s_mov_b64 exec, s[6:7]
ds_read2_b32 v[152:153], v11 offset0:32 offset1:33
ds_read2_b32 v[154:155], v11 offset0:34 offset1:35
ds_read2_b32 v[156:157], v11 offset0:16 offset1:17
ds_read2_b32 v[158:159], v11 offset0:18 offset1:19
ds_read2_b32 v[160:161], v11 offset0:0 offset1:1
ds_read2_b32 v[162:163], v11 offset0:2 offset1:3
ds_read2_b32 v[164:165], v11 offset0:96 offset1:97
ds_read2_b32 v[166:167], v11 offset0:98 offset1:99
ds_read2_b32 v[168:169], v11 offset0:80 offset1:81
ds_read2_b32 v[170:171], v11 offset0:82 offset1:83
ds_read2_b32 v[172:173], v11 offset0:64 offset1:65
ds_read2_b32 v[174:175], v11 offset0:66 offset1:67
ds_read2_b32 v[176:177], v11 offset0:176 offset1:177
ds_read2_b32 v[178:179], v11 offset0:178 offset1:179
ds_read2_b32 v[180:181], v11 offset0:160 offset1:161
ds_read2_b32 v[182:183], v11 offset0:162 offset1:163
ds_read2_b32 v[184:185], v11 offset0:144 offset1:145
ds_read2_b32 v[186:187], v11 offset0:146 offset1:147
ds_read2_b32 v[188:189], v11 offset0:128 offset1:129
ds_read2_b32 v[190:191], v11 offset0:130 offset1:131
s_waitcnt vmcnt(0)
v_and_b32 v132, s5, v224
v_and_b32 v133, s5, v225
v_and_b32 v134, s5, v226
v_and_b32 v135, s5, v227
ds_read_b128 v[136:139], v8 offset:3584
ds_read_b128 v[140:143], v8 offset:3600
ds_read_b128 v[144:147], v8 offset:3072
ds_read_b128 v[148:151], v8 offset:3088
s_waitcnt lgkmcnt(2)
v_mfma_f32_16x16x32_bf16 v[192:195], v[136:139], v[200:203], 0
v_mfma_f32_16x16x32_bf16 v[196:199], v[136:139], v[204:207], 0
v_mfma_f32_16x16x32_bf16 v[236:239], v[140:143], v[212:215], 0
v_mfma_f32_16x16x32_bf16 v[240:243], v[140:143], v[216:219], 0
v_mfma_f32_16x16x32_bf16 v[244:247], v[136:139], v[208:211], 0
v_mfma_f32_16x16x32_bf16 v[248:251], v[140:143], v[220:223], 0
v_mfma_f32_16x16x32_bf16 v[48:51], v[132:135], v[136:139], 0
ds_read2_b32 v[64:65], v9 offset0:0 offset1:1
ds_read2_b32 v[66:67], v9 offset0:2 offset1:3
ds_read2_b32 v[68:69], v9 offset0:16 offset1:17
ds_read2_b32 v[70:71], v9 offset0:18 offset1:19
ds_read2_b32 v[72:73], v9 offset0:32 offset1:33
ds_read2_b32 v[74:75], v9 offset0:34 offset1:35
ds_read_b128 v[136:139], v8 offset:2560
ds_read_b128 v[140:143], v8 offset:2576
v_cvt_pk_bf16_f32 v228, v192, v196
v_cvt_pk_bf16_f32 v229, v193, v197
v_cvt_pk_bf16_f32 v230, v194, v198
v_cvt_pk_bf16_f32 v231, v195, v199
v_cvt_pk_bf16_f32 v232, v236, v240
v_cvt_pk_bf16_f32 v233, v237, v241
v_cvt_pk_bf16_f32 v234, v238, v242
v_cvt_pk_bf16_f32 v235, v239, v243
v_cvt_pk_bf16_f32 v252, v244, v248
v_cvt_pk_bf16_f32 v253, v245, v249
v_cvt_pk_bf16_f32 v254, v246, v250
v_cvt_pk_bf16_f32 v255, v247, v251
s_waitcnt lgkmcnt(2)
v_mfma_f32_16x16x32_bf16 v[192:195], v[144:147], v[200:203], 0
v_mfma_f32_16x16x32_bf16 v[196:199], v[144:147], v[204:207], 0
v_mfma_f32_16x16x32_bf16 v[236:239], v[148:151], v[212:215], 0
v_mfma_f32_16x16x32_bf16 v[240:243], v[148:151], v[216:219], 0
v_mfma_f32_16x16x32_bf16 v[244:247], v[144:147], v[208:211], 0
v_mfma_f32_16x16x32_bf16 v[248:251], v[148:151], v[220:223], 0
v_mfma_f32_16x16x32_bf16 v[52:55], v[132:135], v[144:147], 0
ds_read2_b32 v[76:77], v9 offset0:48 offset1:49
ds_read2_b32 v[78:79], v9 offset0:50 offset1:51
ds_read2_b32 v[80:81], v9 offset0:64 offset1:65
ds_read2_b32 v[82:83], v9 offset0:66 offset1:67
ds_read2_b32 v[84:85], v9 offset0:80 offset1:81
ds_read2_b32 v[86:87], v9 offset0:82 offset1:83
ds_read_b128 v[144:147], v8 offset:2048
ds_read_b128 v[148:151], v8 offset:2064
v_mfma_f32_16x16x32_bf16 v[40:43], v[228:231], v[152:155], 0
v_mfma_f32_16x16x32_bf16 v[40:43], v[232:235], v[164:167], v[40:43]
v_mfma_f32_16x16x32_bf16 v[44:47], v[228:231], v[156:159], 0
v_mfma_f32_16x16x32_bf16 v[44:47], v[232:235], v[168:171], v[44:47]
v_mfma_f32_16x16x32_bf16 v[48:51], v[228:231], v[160:163], v[48:51]
v_mfma_f32_16x16x32_bf16 v[48:51], v[232:235], v[172:175], v[48:51]
v_mfma_f32_16x16x32_bf16 v[48:51], v[252:255], v[176:179], v[48:51]
v_mfma_f32_16x16x32_bf16 v[52:55], v[252:255], v[180:183], v[52:55]
v_mfma_f32_16x16x32_bf16 v[56:59], v[252:255], v[184:187], 0
v_mfma_f32_16x16x32_bf16 v[60:63], v[252:255], v[188:191], 0
v_cvt_pk_bf16_f32 v228, v192, v196
v_cvt_pk_bf16_f32 v229, v193, v197
v_cvt_pk_bf16_f32 v230, v194, v198
v_cvt_pk_bf16_f32 v231, v195, v199
v_cvt_pk_bf16_f32 v232, v236, v240
v_cvt_pk_bf16_f32 v233, v237, v241
v_cvt_pk_bf16_f32 v234, v238, v242
v_cvt_pk_bf16_f32 v235, v239, v243
v_cvt_pk_bf16_f32 v252, v244, v248
v_cvt_pk_bf16_f32 v253, v245, v249
v_cvt_pk_bf16_f32 v254, v246, v250
v_cvt_pk_bf16_f32 v255, v247, v251
s_waitcnt lgkmcnt(2)
v_mfma_f32_16x16x32_bf16 v[192:195], v[136:139], v[200:203], 0
v_mfma_f32_16x16x32_bf16 v[196:199], v[136:139], v[204:207], 0
v_mfma_f32_16x16x32_bf16 v[236:239], v[140:143], v[212:215], 0
v_mfma_f32_16x16x32_bf16 v[240:243], v[140:143], v[216:219], 0
v_mfma_f32_16x16x32_bf16 v[244:247], v[136:139], v[208:211], 0
v_mfma_f32_16x16x32_bf16 v[248:251], v[140:143], v[220:223], 0
v_mfma_f32_16x16x32_bf16 v[56:59], v[132:135], v[136:139], v[56:59]
ds_read2_b32 v[88:89], v9 offset0:96 offset1:97
ds_read2_b32 v[90:91], v9 offset0:98 offset1:99
ds_read2_b32 v[92:93], v9 offset0:112 offset1:113
ds_read2_b32 v[94:95], v9 offset0:114 offset1:115
ds_read2_b32 v[96:97], v9 offset0:128 offset1:129
ds_read2_b32 v[98:99], v9 offset0:130 offset1:131
ds_read_b128 v[136:139], v8 offset:1536
ds_read_b128 v[140:143], v8 offset:1552
v_mfma_f32_16x16x32_bf16 v[44:47], v[228:231], v[152:155], v[44:47]
v_mfma_f32_16x16x32_bf16 v[44:47], v[232:235], v[164:167], v[44:47]
v_mfma_f32_16x16x32_bf16 v[48:51], v[228:231], v[156:159], v[48:51]
v_mfma_f32_16x16x32_bf16 v[48:51], v[232:235], v[168:171], v[48:51]
v_mfma_f32_16x16x32_bf16 v[52:55], v[228:231], v[160:163], v[52:55]
v_mfma_f32_16x16x32_bf16 v[52:55], v[232:235], v[172:175], v[52:55]
v_mfma_f32_16x16x32_bf16 v[52:55], v[252:255], v[176:179], v[52:55]
v_mfma_f32_16x16x32_bf16 v[56:59], v[252:255], v[180:183], v[56:59]
v_mfma_f32_16x16x32_bf16 v[60:63], v[252:255], v[184:187], v[60:63]
v_cvt_pk_bf16_f32 v228, v192, v196
v_cvt_pk_bf16_f32 v229, v193, v197
v_cvt_pk_bf16_f32 v230, v194, v198
v_cvt_pk_bf16_f32 v231, v195, v199
v_cvt_pk_bf16_f32 v232, v236, v240
v_cvt_pk_bf16_f32 v233, v237, v241
v_cvt_pk_bf16_f32 v234, v238, v242
v_cvt_pk_bf16_f32 v235, v239, v243
v_cvt_pk_bf16_f32 v252, v244, v248
v_cvt_pk_bf16_f32 v253, v245, v249
v_cvt_pk_bf16_f32 v254, v246, v250
v_cvt_pk_bf16_f32 v255, v247, v251
s_waitcnt lgkmcnt(2)
v_mfma_f32_16x16x32_bf16 v[192:195], v[144:147], v[200:203], 0
v_mfma_f32_16x16x32_bf16 v[196:199], v[144:147], v[204:207], 0
v_mfma_f32_16x16x32_bf16 v[236:239], v[148:151], v[212:215], 0
v_mfma_f32_16x16x32_bf16 v[240:243], v[148:151], v[216:219], 0
v_mfma_f32_16x16x32_bf16 v[244:247], v[144:147], v[208:211], 0
v_mfma_f32_16x16x32_bf16 v[248:251], v[148:151], v[220:223], 0
v_mfma_f32_16x16x32_bf16 v[60:63], v[132:135], v[144:147], v[60:63]
ds_read2_b32 v[100:101], v9 offset0:144 offset1:145
ds_read2_b32 v[102:103], v9 offset0:146 offset1:147
ds_read2_b32 v[104:105], v9 offset0:160 offset1:161
ds_read2_b32 v[106:107], v9 offset0:162 offset1:163
ds_read2_b32 v[108:109], v9 offset0:176 offset1:177
ds_read2_b32 v[110:111], v9 offset0:178 offset1:179
ds_read_b128 v[144:147], v8 offset:1024
ds_read_b128 v[148:151], v8 offset:1040
v_mfma_f32_16x16x32_bf16 v[48:51], v[228:231], v[152:155], v[48:51]
v_mfma_f32_16x16x32_bf16 v[48:51], v[232:235], v[164:167], v[48:51]
v_mfma_f32_16x16x32_bf16 v[52:55], v[228:231], v[156:159], v[52:55]
v_mfma_f32_16x16x32_bf16 v[52:55], v[232:235], v[168:171], v[52:55]
v_mfma_f32_16x16x32_bf16 v[56:59], v[228:231], v[160:163], v[56:59]
v_mfma_f32_16x16x32_bf16 v[56:59], v[232:235], v[172:175], v[56:59]
v_mfma_f32_16x16x32_bf16 v[56:59], v[252:255], v[176:179], v[56:59]
v_mfma_f32_16x16x32_bf16 v[60:63], v[252:255], v[180:183], v[60:63]
v_cvt_pk_bf16_f32 v228, v192, v196
v_cvt_pk_bf16_f32 v229, v193, v197
v_cvt_pk_bf16_f32 v230, v194, v198
v_cvt_pk_bf16_f32 v231, v195, v199
v_cvt_pk_bf16_f32 v232, v236, v240
v_cvt_pk_bf16_f32 v233, v237, v241
v_cvt_pk_bf16_f32 v234, v238, v242
v_cvt_pk_bf16_f32 v235, v239, v243
v_cvt_pk_bf16_f32 v252, v244, v248
v_cvt_pk_bf16_f32 v253, v245, v249
v_cvt_pk_bf16_f32 v254, v246, v250
v_cvt_pk_bf16_f32 v255, v247, v251
s_waitcnt lgkmcnt(2)
v_mfma_f32_16x16x32_bf16 v[192:195], v[136:139], v[200:203], 0
v_mfma_f32_16x16x32_bf16 v[196:199], v[136:139], v[204:207], 0
v_mfma_f32_16x16x32_bf16 v[236:239], v[140:143], v[212:215], 0
v_mfma_f32_16x16x32_bf16 v[240:243], v[140:143], v[216:219], 0
ds_read2_b32 v[112:113], v9 offset0:192 offset1:193
ds_read2_b32 v[114:115], v9 offset0:194 offset1:195
ds_read2_b32 v[116:117], v9 offset0:208 offset1:209
ds_read2_b32 v[118:119], v9 offset0:210 offset1:211
ds_read2_b32 v[120:121], v9 offset0:224 offset1:225
ds_read2_b32 v[122:123], v9 offset0:226 offset1:227
v_mfma_f32_16x16x32_bf16 v[52:55], v[228:231], v[152:155], v[52:55]
v_mfma_f32_16x16x32_bf16 v[52:55], v[232:235], v[164:167], v[52:55]
v_mfma_f32_16x16x32_bf16 v[56:59], v[228:231], v[156:159], v[56:59]
v_mfma_f32_16x16x32_bf16 v[56:59], v[232:235], v[168:171], v[56:59]
v_mfma_f32_16x16x32_bf16 v[60:63], v[228:231], v[160:163], v[60:63]
v_mfma_f32_16x16x32_bf16 v[60:63], v[232:235], v[172:175], v[60:63]
v_mfma_f32_16x16x32_bf16 v[60:63], v[252:255], v[176:179], v[60:63]
v_cvt_pk_bf16_f32 v228, v192, v196
v_cvt_pk_bf16_f32 v229, v193, v197
v_cvt_pk_bf16_f32 v230, v194, v198
v_cvt_pk_bf16_f32 v231, v195, v199
v_cvt_pk_bf16_f32 v232, v236, v240
v_cvt_pk_bf16_f32 v233, v237, v241
v_cvt_pk_bf16_f32 v234, v238, v242
v_cvt_pk_bf16_f32 v235, v239, v243
s_waitcnt lgkmcnt(0)
v_mfma_f32_16x16x32_bf16 v[192:195], v[144:147], v[200:203], 0
v_mfma_f32_16x16x32_bf16 v[196:199], v[144:147], v[204:207], 0
v_mfma_f32_16x16x32_bf16 v[236:239], v[148:151], v[212:215], 0
v_mfma_f32_16x16x32_bf16 v[240:243], v[148:151], v[216:219], 0
ds_read2_b32 v[124:125], v9 offset0:240 offset1:241
ds_read2_b32 v[126:127], v9 offset0:242 offset1:243
ds_read2_b32 v[128:129], v10 offset0:0 offset1:1
ds_read2_b32 v[130:131], v10 offset0:2 offset1:3
v_mfma_f32_16x16x32_bf16 v[56:59], v[228:231], v[152:155], v[56:59]
v_mfma_f32_16x16x32_bf16 v[56:59], v[232:235], v[164:167], v[56:59]
v_mfma_f32_16x16x32_bf16 v[60:63], v[228:231], v[156:159], v[60:63]
v_mfma_f32_16x16x32_bf16 v[60:63], v[232:235], v[168:171], v[60:63]
v_cvt_pk_bf16_f32 v228, v192, v196
v_cvt_pk_bf16_f32 v229, v193, v197
v_cvt_pk_bf16_f32 v230, v194, v198
v_cvt_pk_bf16_f32 v231, v195, v199
v_cvt_pk_bf16_f32 v232, v236, v240
v_cvt_pk_bf16_f32 v233, v237, v241
v_cvt_pk_bf16_f32 v234, v238, v242
v_cvt_pk_bf16_f32 v235, v239, v243
v_mfma_f32_16x16x32_bf16 v[60:63], v[228:231], v[152:155], v[60:63]
s_nop 0
v_mfma_f32_16x16x32_bf16 v[60:63], v[232:235], v[164:167], v[60:63]
s_add_u32 s48, s46, 0x1000000
s_addc_u32 s49, s47, 0
s_mov_b32 s50, 0x280000
s_mov_b32 s51, 0x20000
s_add_u32 s52, s46, 0xf20000
s_addc_u32 s53, s47, 0
s_mov_b32 s54, 0x5000
s_mov_b32 s55, 0x20000
v_lshlrev_b32 v12, 5, v3
v_lshrrev_b32 v13, 1, v4
v_lshl_add_u32 v12, v13, 4, v12
v_and_b32 v13, 1, v4
v_lshl_add_u32 v12, v13, 9, v12
s_waitcnt lgkmcnt(0)
ds_read_b128 v[136:139], v8 offset:0
ds_read_b128 v[140:143], v8 offset:64
ds_read_b128 v[144:147], v8 offset:128
ds_read_b128 v[148:151], v8 offset:192
s_waitcnt lgkmcnt(3)
v_mfma_f32_16x16x32_bf16 v[60:63], v[64:67], v[136:139], v[60:63]
ds_read_b128 v[136:139], v8 offset:256
s_waitcnt lgkmcnt(3)
v_mfma_f32_16x16x32_bf16 v[60:63], v[68:71], v[140:143], v[60:63]
ds_read_b128 v[140:143], v8 offset:320
s_waitcnt lgkmcnt(3)
v_mfma_f32_16x16x32_bf16 v[60:63], v[72:75], v[144:147], v[60:63]
ds_read_b128 v[144:147], v8 offset:384
s_waitcnt lgkmcnt(3)
v_mfma_f32_16x16x32_bf16 v[60:63], v[76:79], v[148:151], v[60:63]
ds_read_b128 v[148:151], v8 offset:448
s_waitcnt lgkmcnt(3)
v_mfma_f32_16x16x32_bf16 v[60:63], v[80:83], v[136:139], v[60:63]
ds_read_b128 v[136:139], v8 offset:512
s_waitcnt lgkmcnt(3)
v_mfma_f32_16x16x32_bf16 v[60:63], v[84:87], v[140:143], v[60:63]
ds_read_b128 v[140:143], v8 offset:576
s_waitcnt lgkmcnt(3)
v_mfma_f32_16x16x32_bf16 v[60:63], v[88:91], v[144:147], v[60:63]
ds_read_b128 v[144:147], v8 offset:640
s_waitcnt lgkmcnt(3)
v_mfma_f32_16x16x32_bf16 v[60:63], v[92:95], v[148:151], v[60:63]
ds_read_b128 v[148:151], v8 offset:704
s_waitcnt lgkmcnt(3)
v_mfma_f32_16x16x32_bf16 v[56:59], v[64:67], v[136:139], v[56:59]
v_mfma_f32_16x16x32_bf16 v[60:63], v[96:99], v[136:139], v[60:63]
ds_read_b128 v[136:139], v8 offset:768
s_waitcnt lgkmcnt(3)
v_mfma_f32_16x16x32_bf16 v[56:59], v[68:71], v[140:143], v[56:59]
v_mfma_f32_16x16x32_bf16 v[60:63], v[100:103], v[140:143], v[60:63]
ds_read_b128 v[140:143], v8 offset:832
s_waitcnt lgkmcnt(3)
v_mfma_f32_16x16x32_bf16 v[56:59], v[72:75], v[144:147], v[56:59]
v_mfma_f32_16x16x32_bf16 v[60:63], v[104:107], v[144:147], v[60:63]
ds_read_b128 v[144:147], v8 offset:896
s_waitcnt lgkmcnt(3)
v_mfma_f32_16x16x32_bf16 v[56:59], v[76:79], v[148:151], v[56:59]
v_mfma_f32_16x16x32_bf16 v[60:63], v[108:111], v[148:151], v[60:63]
ds_read_b128 v[148:151], v8 offset:960
s_waitcnt lgkmcnt(3)
v_mfma_f32_16x16x32_bf16 v[56:59], v[80:83], v[136:139], v[56:59]
v_mfma_f32_16x16x32_bf16 v[60:63], v[112:115], v[136:139], v[60:63]
ds_read_b128 v[136:139], v8 offset:1024
s_waitcnt lgkmcnt(3)
v_mfma_f32_16x16x32_bf16 v[56:59], v[84:87], v[140:143], v[56:59]
v_mfma_f32_16x16x32_bf16 v[60:63], v[116:119], v[140:143], v[60:63]
ds_read_b128 v[140:143], v8 offset:1088
s_waitcnt lgkmcnt(3)
v_mfma_f32_16x16x32_bf16 v[56:59], v[88:91], v[144:147], v[56:59]
v_mfma_f32_16x16x32_bf16 v[60:63], v[120:123], v[144:147], v[60:63]
ds_read_b128 v[144:147], v8 offset:1152
s_waitcnt lgkmcnt(3)
v_mfma_f32_16x16x32_bf16 v[56:59], v[92:95], v[148:151], v[56:59]
v_mfma_f32_16x16x32_bf16 v[60:63], v[124:127], v[148:151], v[60:63]
ds_read_b128 v[148:151], v8 offset:1216
s_waitcnt lgkmcnt(3)
v_mfma_f32_16x16x32_bf16 v[52:55], v[64:67], v[136:139], v[52:55]
v_mfma_f32_16x16x32_bf16 v[56:59], v[96:99], v[136:139], v[56:59]
v_mfma_f32_16x16x32_bf16 v[60:63], v[128:131], v[136:139], v[60:63]
ds_read_b128 v[136:139], v8 offset:1280
s_waitcnt lgkmcnt(3)
v_mfma_f32_16x16x32_bf16 v[52:55], v[68:71], v[140:143], v[52:55]
v_mfma_f32_16x16x32_bf16 v[56:59], v[100:103], v[140:143], v[56:59]
ds_read_b128 v[140:143], v8 offset:1344
s_waitcnt lgkmcnt(3)
v_mfma_f32_16x16x32_bf16 v[52:55], v[72:75], v[144:147], v[52:55]
v_mfma_f32_16x16x32_bf16 v[56:59], v[104:107], v[144:147], v[56:59]
ds_read_b128 v[144:147], v8 offset:1408
s_waitcnt lgkmcnt(3)
v_mfma_f32_16x16x32_bf16 v[52:55], v[76:79], v[148:151], v[52:55]
v_mfma_f32_16x16x32_bf16 v[56:59], v[108:111], v[148:151], v[56:59]
ds_read_b128 v[148:151], v8 offset:1472
s_waitcnt lgkmcnt(3)
v_mfma_f32_16x16x32_bf16 v[52:55], v[80:83], v[136:139], v[52:55]
v_mfma_f32_16x16x32_bf16 v[56:59], v[112:115], v[136:139], v[56:59]
ds_read_b128 v[136:139], v8 offset:1536
s_waitcnt lgkmcnt(3)
v_mfma_f32_16x16x32_bf16 v[52:55], v[84:87], v[140:143], v[52:55]
v_mfma_f32_16x16x32_bf16 v[56:59], v[116:119], v[140:143], v[56:59]
ds_read_b128 v[140:143], v8 offset:1600
s_waitcnt lgkmcnt(3)
v_mfma_f32_16x16x32_bf16 v[52:55], v[88:91], v[144:147], v[52:55]
v_mfma_f32_16x16x32_bf16 v[56:59], v[120:123], v[144:147], v[56:59]
ds_read_b128 v[144:147], v8 offset:1664
s_waitcnt lgkmcnt(3)
v_mfma_f32_16x16x32_bf16 v[52:55], v[92:95], v[148:151], v[52:55]
v_mfma_f32_16x16x32_bf16 v[56:59], v[124:127], v[148:151], v[56:59]
ds_read_b128 v[148:151], v8 offset:1728
s_waitcnt lgkmcnt(3)
v_mfma_f32_16x16x32_bf16 v[48:51], v[64:67], v[136:139], v[48:51]
v_mfma_f32_16x16x32_bf16 v[52:55], v[96:99], v[136:139], v[52:55]
v_mfma_f32_16x16x32_bf16 v[56:59], v[128:131], v[136:139], v[56:59]
s_nop 7
v_cvt_pk_bf16_f32 v164, v56, v57
v_cvt_pk_bf16_f32 v165, v58, v59
v_cvt_pk_bf16_f32 v166, v60, v61
v_cvt_pk_bf16_f32 v167, v62, v63
s_nop 0
v_permlane16_swap_b32 v164, v166
v_permlane16_swap_b32 v165, v167
buffer_store_dwordx4 v[164:167], v12, s[48:51], s12 offen offset:3072 sc1
ds_read_b128 v[136:139], v8 offset:1792
s_waitcnt lgkmcnt(3)
v_mfma_f32_16x16x32_bf16 v[48:51], v[68:71], v[140:143], v[48:51]
v_mfma_f32_16x16x32_bf16 v[52:55], v[100:103], v[140:143], v[52:55]
ds_read_b128 v[140:143], v8 offset:1856
s_waitcnt lgkmcnt(3)
v_mfma_f32_16x16x32_bf16 v[48:51], v[72:75], v[144:147], v[48:51]
v_mfma_f32_16x16x32_bf16 v[52:55], v[104:107], v[144:147], v[52:55]
ds_read_b128 v[144:147], v8 offset:1920
s_waitcnt lgkmcnt(3)
v_mfma_f32_16x16x32_bf16 v[48:51], v[76:79], v[148:151], v[48:51]
v_mfma_f32_16x16x32_bf16 v[52:55], v[108:111], v[148:151], v[52:55]
ds_read_b128 v[148:151], v8 offset:1984
s_waitcnt lgkmcnt(3)
v_mfma_f32_16x16x32_bf16 v[48:51], v[80:83], v[136:139], v[48:51]
v_mfma_f32_16x16x32_bf16 v[52:55], v[112:115], v[136:139], v[52:55]
ds_read_b128 v[136:139], v8 offset:2048
s_waitcnt lgkmcnt(3)
v_mfma_f32_16x16x32_bf16 v[48:51], v[84:87], v[140:143], v[48:51]
v_mfma_f32_16x16x32_bf16 v[52:55], v[116:119], v[140:143], v[52:55]
ds_read_b128 v[140:143], v8 offset:2112
s_waitcnt lgkmcnt(3)
v_mfma_f32_16x16x32_bf16 v[48:51], v[88:91], v[144:147], v[48:51]
v_mfma_f32_16x16x32_bf16 v[52:55], v[120:123], v[144:147], v[52:55]
ds_read_b128 v[144:147], v8 offset:2176
s_waitcnt lgkmcnt(3)
v_mfma_f32_16x16x32_bf16 v[48:51], v[92:95], v[148:151], v[48:51]
v_mfma_f32_16x16x32_bf16 v[52:55], v[124:127], v[148:151], v[52:55]
ds_read_b128 v[148:151], v8 offset:2240
s_waitcnt lgkmcnt(3)
v_mfma_f32_16x16x32_bf16 v[44:47], v[64:67], v[136:139], v[44:47]
v_mfma_f32_16x16x32_bf16 v[48:51], v[96:99], v[136:139], v[48:51]
v_mfma_f32_16x16x32_bf16 v[52:55], v[128:131], v[136:139], v[52:55]
ds_read_b128 v[136:139], v8 offset:2304
s_waitcnt lgkmcnt(3)
v_mfma_f32_16x16x32_bf16 v[44:47], v[68:71], v[140:143], v[44:47]
v_mfma_f32_16x16x32_bf16 v[48:51], v[100:103], v[140:143], v[48:51]
ds_read_b128 v[140:143], v8 offset:2368
s_waitcnt lgkmcnt(3)
v_mfma_f32_16x16x32_bf16 v[44:47], v[72:75], v[144:147], v[44:47]
v_mfma_f32_16x16x32_bf16 v[48:51], v[104:107], v[144:147], v[48:51]
ds_read_b128 v[144:147], v8 offset:2432
s_waitcnt lgkmcnt(3)
v_mfma_f32_16x16x32_bf16 v[44:47], v[76:79], v[148:151], v[44:47]
v_mfma_f32_16x16x32_bf16 v[48:51], v[108:111], v[148:151], v[48:51]
ds_read_b128 v[148:151], v8 offset:2496
s_waitcnt lgkmcnt(3)
v_mfma_f32_16x16x32_bf16 v[44:47], v[80:83], v[136:139], v[44:47]
v_mfma_f32_16x16x32_bf16 v[48:51], v[112:115], v[136:139], v[48:51]
ds_read_b128 v[136:139], v8 offset:2560
s_waitcnt lgkmcnt(3)
v_mfma_f32_16x16x32_bf16 v[44:47], v[84:87], v[140:143], v[44:47]
v_mfma_f32_16x16x32_bf16 v[48:51], v[116:119], v[140:143], v[48:51]
ds_read_b128 v[140:143], v8 offset:2624
s_waitcnt lgkmcnt(3)
v_mfma_f32_16x16x32_bf16 v[44:47], v[88:91], v[144:147], v[44:47]
v_mfma_f32_16x16x32_bf16 v[48:51], v[120:123], v[144:147], v[48:51]
ds_read_b128 v[144:147], v8 offset:2688
s_waitcnt lgkmcnt(3)
v_mfma_f32_16x16x32_bf16 v[44:47], v[92:95], v[148:151], v[44:47]
v_mfma_f32_16x16x32_bf16 v[48:51], v[124:127], v[148:151], v[48:51]
ds_read_b128 v[148:151], v8 offset:2752
s_waitcnt lgkmcnt(3)
v_mfma_f32_16x16x32_bf16 v[40:43], v[64:67], v[136:139], v[40:43]
v_mfma_f32_16x16x32_bf16 v[44:47], v[96:99], v[136:139], v[44:47]
v_mfma_f32_16x16x32_bf16 v[48:51], v[128:131], v[136:139], v[48:51]
s_nop 7
v_cvt_pk_bf16_f32 v160, v48, v49
v_cvt_pk_bf16_f32 v161, v50, v51
v_cvt_pk_bf16_f32 v162, v52, v53
v_cvt_pk_bf16_f32 v163, v54, v55
s_nop 0
v_permlane16_swap_b32 v160, v162
v_permlane16_swap_b32 v161, v163
buffer_store_dwordx4 v[160:163], v12, s[48:51], s12 offen offset:2048 sc1
ds_read_b128 v[136:139], v8 offset:2816
s_waitcnt lgkmcnt(3)
v_mfma_f32_16x16x32_bf16 v[40:43], v[68:71], v[140:143], v[40:43]
v_mfma_f32_16x16x32_bf16 v[44:47], v[100:103], v[140:143], v[44:47]
ds_read_b128 v[140:143], v8 offset:2880
s_waitcnt lgkmcnt(3)
v_mfma_f32_16x16x32_bf16 v[40:43], v[72:75], v[144:147], v[40:43]
v_mfma_f32_16x16x32_bf16 v[44:47], v[104:107], v[144:147], v[44:47]
ds_read_b128 v[144:147], v8 offset:2944
s_waitcnt lgkmcnt(3)
v_mfma_f32_16x16x32_bf16 v[40:43], v[76:79], v[148:151], v[40:43]
v_mfma_f32_16x16x32_bf16 v[44:47], v[108:111], v[148:151], v[44:47]
ds_read_b128 v[148:151], v8 offset:3008
s_waitcnt lgkmcnt(3)
v_mfma_f32_16x16x32_bf16 v[40:43], v[80:83], v[136:139], v[40:43]
v_mfma_f32_16x16x32_bf16 v[44:47], v[112:115], v[136:139], v[44:47]
ds_read_b128 v[136:139], v8 offset:3072
s_waitcnt lgkmcnt(3)
v_mfma_f32_16x16x32_bf16 v[40:43], v[84:87], v[140:143], v[40:43]
v_mfma_f32_16x16x32_bf16 v[44:47], v[116:119], v[140:143], v[44:47]
ds_read_b128 v[140:143], v8 offset:3136
s_waitcnt lgkmcnt(3)
v_mfma_f32_16x16x32_bf16 v[40:43], v[88:91], v[144:147], v[40:43]
v_mfma_f32_16x16x32_bf16 v[44:47], v[120:123], v[144:147], v[44:47]
ds_read_b128 v[144:147], v8 offset:3200
s_waitcnt lgkmcnt(3)
v_mfma_f32_16x16x32_bf16 v[40:43], v[92:95], v[148:151], v[40:43]
v_mfma_f32_16x16x32_bf16 v[44:47], v[124:127], v[148:151], v[44:47]
ds_read_b128 v[148:151], v8 offset:3264
s_waitcnt lgkmcnt(3)
v_mfma_f32_16x16x32_bf16 v[36:39], v[64:67], v[136:139], 0
v_mfma_f32_16x16x32_bf16 v[40:43], v[96:99], v[136:139], v[40:43]
v_mfma_f32_16x16x32_bf16 v[44:47], v[128:131], v[136:139], v[44:47]
ds_read_b128 v[136:139], v8 offset:3328
s_waitcnt lgkmcnt(3)
v_mfma_f32_16x16x32_bf16 v[36:39], v[68:71], v[140:143], v[36:39]
v_mfma_f32_16x16x32_bf16 v[40:43], v[100:103], v[140:143], v[40:43]
ds_read_b128 v[140:143], v8 offset:3392
s_waitcnt lgkmcnt(3)
v_mfma_f32_16x16x32_bf16 v[36:39], v[72:75], v[144:147], v[36:39]
v_mfma_f32_16x16x32_bf16 v[40:43], v[104:107], v[144:147], v[40:43]
ds_read_b128 v[144:147], v8 offset:3456
s_waitcnt lgkmcnt(3)
v_mfma_f32_16x16x32_bf16 v[36:39], v[76:79], v[148:151], v[36:39]
v_mfma_f32_16x16x32_bf16 v[40:43], v[108:111], v[148:151], v[40:43]
ds_read_b128 v[148:151], v8 offset:3520
s_waitcnt lgkmcnt(3)
v_mfma_f32_16x16x32_bf16 v[36:39], v[80:83], v[136:139], v[36:39]
v_mfma_f32_16x16x32_bf16 v[40:43], v[112:115], v[136:139], v[40:43]
ds_read_b128 v[136:139], v8 offset:3584
s_waitcnt lgkmcnt(3)
v_mfma_f32_16x16x32_bf16 v[36:39], v[84:87], v[140:143], v[36:39]
v_mfma_f32_16x16x32_bf16 v[40:43], v[116:119], v[140:143], v[40:43]
ds_read_b128 v[140:143], v8 offset:3648
s_waitcnt lgkmcnt(3)
v_mfma_f32_16x16x32_bf16 v[36:39], v[88:91], v[144:147], v[36:39]
v_mfma_f32_16x16x32_bf16 v[40:43], v[120:123], v[144:147], v[40:43]
ds_read_b128 v[144:147], v8 offset:3712
s_waitcnt lgkmcnt(3)
v_mfma_f32_16x16x32_bf16 v[36:39], v[92:95], v[148:151], v[36:39]
v_mfma_f32_16x16x32_bf16 v[40:43], v[124:127], v[148:151], v[40:43]
ds_read_b128 v[148:151], v8 offset:3776
s_waitcnt lgkmcnt(3)
v_mfma_f32_16x16x32_bf16 v[32:35], v[64:67], v[136:139], 0
v_mfma_f32_16x16x32_bf16 v[36:39], v[96:99], v[136:139], v[36:39]
v_mfma_f32_16x16x32_bf16 v[40:43], v[128:131], v[136:139], v[40:43]
s_nop 7
v_cvt_pk_bf16_f32 v156, v40, v41
v_cvt_pk_bf16_f32 v157, v42, v43
v_cvt_pk_bf16_f32 v158, v44, v45
v_cvt_pk_bf16_f32 v159, v46, v47
s_nop 0
v_permlane16_swap_b32 v156, v158
v_permlane16_swap_b32 v157, v159
buffer_store_dwordx4 v[156:159], v12, s[48:51], s12 offen offset:1024 sc1
ds_read_b128 v[136:139], v8 offset:3840
s_waitcnt lgkmcnt(3)
v_mfma_f32_16x16x32_bf16 v[32:35], v[68:71], v[140:143], v[32:35]
v_mfma_f32_16x16x32_bf16 v[36:39], v[100:103], v[140:143], v[36:39]
ds_read_b128 v[140:143], v8 offset:3904
s_waitcnt lgkmcnt(3)
v_mfma_f32_16x16x32_bf16 v[32:35], v[72:75], v[144:147], v[32:35]
v_mfma_f32_16x16x32_bf16 v[36:39], v[104:107], v[144:147], v[36:39]
ds_read_b128 v[144:147], v8 offset:3968
s_waitcnt lgkmcnt(3)
v_mfma_f32_16x16x32_bf16 v[32:35], v[76:79], v[148:151], v[32:35]
v_mfma_f32_16x16x32_bf16 v[36:39], v[108:111], v[148:151], v[36:39]
ds_read_b128 v[148:151], v8 offset:4032
s_waitcnt lgkmcnt(3)
v_mfma_f32_16x16x32_bf16 v[32:35], v[80:83], v[136:139], v[32:35]
v_mfma_f32_16x16x32_bf16 v[36:39], v[112:115], v[136:139], v[36:39]
s_waitcnt lgkmcnt(2)
v_mfma_f32_16x16x32_bf16 v[32:35], v[84:87], v[140:143], v[32:35]
v_mfma_f32_16x16x32_bf16 v[36:39], v[116:119], v[140:143], v[36:39]
s_waitcnt lgkmcnt(1)
v_mfma_f32_16x16x32_bf16 v[32:35], v[88:91], v[144:147], v[32:35]
v_mfma_f32_16x16x32_bf16 v[36:39], v[120:123], v[144:147], v[36:39]
s_waitcnt lgkmcnt(0)
v_mfma_f32_16x16x32_bf16 v[32:35], v[92:95], v[148:151], v[32:35]
v_mfma_f32_16x16x32_bf16 v[36:39], v[124:127], v[148:151], v[36:39]
s_nop 6
v_cvt_pk_bf16_f32 v152, v32, v33
v_cvt_pk_bf16_f32 v153, v34, v35
v_cvt_pk_bf16_f32 v154, v36, v37
v_cvt_pk_bf16_f32 v155, v38, v39
s_nop 0
v_permlane16_swap_b32 v152, v154
v_permlane16_swap_b32 v153, v155
buffer_store_dwordx4 v[152:155], v12, s[48:51], s12 offen offset:0 sc1
s_sub_u32 s13, s2, 256
s_lshl_b32 s13, s13, 7
v_mov_b32 v13, s13
v_mov_b32 v14, 1
s_waitcnt vmcnt(0)
s_barrier
s_cmp_lg_u32 s8, 0
s_cbranch_scc1 SNS_16
v_cmp_eq_u32 vcc, 0, v2
s_nop 0
s_and_saveexec_b64 s[6:7], vcc
buffer_store_dword v14, v13, s[52:55], 0 offen sc1
s_mov_b64 exec, s[6:7]
SNS_16:
s_endpgm
K2_END:
s_endpgm
.section .rodata,"a"
.p2align 6
.amdhsa_kernel k1_kernel
  .amdhsa_next_free_vgpr 256
  .amdhsa_next_free_sgpr 102
  .amdhsa_accum_offset 256
  .amdhsa_group_segment_fixed_size 0
  .amdhsa_kernarg_size 128
  .amdhsa_user_sgpr_count 2
  .amdhsa_user_sgpr_kernarg_segment_ptr 1
  .amdhsa_system_sgpr_workgroup_id_x 1
.end_amdhsa_kernel
.p2align 6
.amdhsa_kernel k2_kernel
  .amdhsa_next_free_vgpr 256
  .amdhsa_next_free_sgpr 102
  .amdhsa_accum_offset 256
  .amdhsa_group_segment_fixed_size 0
  .amdhsa_kernarg_size 128
  .amdhsa_user_sgpr_count 2
  .amdhsa_user_sgpr_kernarg_segment_ptr 1
  .amdhsa_system_sgpr_workgroup_id_x 1
.end_amdhsa_kernel
```
